```python
import torch

def _softmax(x, axis=-1):
    return torch.softmax(x, dim=axis)
def _gelu(x):
    return torch.nn.functional.gelu(x, approximate="tanh")
def _silu(x):
    return torch.nn.functional.silu(x)
def _sigmoid(x):
    return torch.sigmoid(x)
def _layernorm(x, axis=-1, eps=1e-5):
    m = x.mean(dim=axis, keepdim=True)
    v = x.var(dim=axis, keepdim=True, unbiased=False)
    return (x - m) / torch.sqrt(v + eps)
def _scatter_add(tgt, idx, src, axis=0):
    return tgt.clone().index_add_(axis, idx, src)
def _segment_sum(src, seg, n):
    out = torch.zeros((n,) + src.shape[1:], dtype=src.dtype)
    return out.index_add_(0, seg, src)
def _pad(x, pw):
    flat = tuple(v for pair in reversed(pw) for v in pair)
    return torch.nn.functional.pad(x, flat)

kernel_name = 'standalone__linear_kernel_hedgehog__prompt'

def setup_inputs():

    _w = (lambda a: (lambda t: t.to(torch.bfloat16) if t.is_floating_point() else t)(torch.as_tensor(a)))
    B, S, D, H = 1, 2048, 640, 32
    Dh = D // H
    return {
        "x": _w((lambda *s: torch.randn(*s, dtype=torch.bfloat16) * 0.4)(B, S, D)),
        "wqkv": _w((lambda *s: torch.randn(*s, dtype=torch.bfloat16) * 0.4)(D, 3 * D)),
        "w_phi": _w((lambda *s: torch.randn(*s, dtype=torch.bfloat16) * 0.4)(H, Dh, Dh) * (Dh ** -0.5)),
        "wo": _w((lambda *s: torch.randn(*s, dtype=torch.bfloat16) * 0.05)(D, D)),
    }

def reference(x, wqkv, w_phi, wo):
    B, S, D = x.shape
    H = 32; Dh = D // H
    qkv = (lambda x, *d: x.permute(*d))((x @ wqkv).reshape(B, S, 3, H, Dh), 2, 0, 3, 1, 4)
    q, k, v = qkv[0], qkv[1], qkv[2]
    pq = torch.einsum("bhsd,hdf->bhsf", q, w_phi)
    pk = torch.einsum("bhsd,hdf->bhsf", k, w_phi)
    phi_q = torch.concatenate([_softmax(pq, axis=-1), _softmax(-pq, axis=-1)], axis=-1)
    phi_k = torch.concatenate([_softmax(pk, axis=-1), _softmax(-pk, axis=-1)], axis=-1)
    kv = torch.einsum("bhsf,bhsd->bhfd", phi_k, v)
    z  = torch.einsum("bhsf->bhf", phi_k)
    num = torch.einsum("bhqf,bhfd->bhqd", phi_q, kv)
    den = torch.einsum("bhqf,bhf->bhq", phi_q, z)[..., None] + 1e-6
    o = num / den
    return (lambda x, *d: x.permute(*d))(o, 0, 2, 1, 3).reshape(B, S, D) @ wo
```

```asm
; @launch grid=(256,1,1) block=(256,1,1) lds=163840
.amdgcn_target "amdgcn-amd-amdhsa--gfx950"
.text
.globl standalone__linear_kernel_hedgehog__prompt_kernel
.p2align 8
.type standalone__linear_kernel_hedgehog__prompt_kernel,@function
standalone__linear_kernel_hedgehog__prompt_kernel:
  s_cmp_ge_u32 s2, 256
  s_cbranch_scc1 L_end
  s_load_dwordx8 s[84:91], s[0:1], 0
  s_load_dwordx4 s[92:95], s[0:1], 32
  s_load_dwordx2 s[96:97], s[0:1], 48
  v_and_b32 v1, 63, v0
  v_lshrrev_b32 v56, 6, v0
  s_nop 0
  v_readfirstlane_b32 s40, v56
  s_and_b32 s46, s2, 7
  s_lshr_b32 s49, s2, 3
  s_lshr_b32 s50, s49, 4
  s_lshl_b32 s41, s46, 1
  s_add_u32 s41, s41, s50
  s_and_b32 s42, s49, 15
  s_and_b32 s45, s49, 7
  s_lshr_b32 s51, s49, 3
  s_lshl_b32 s44, s46, 2
  s_add_u32 s44, s44, s51
  s_mul_i32 s43, s42, 3
  s_mul_i32 s50, s50, 5
  s_add_u32 s43, s43, s50
  s_mul_i32 s50, s46, 3
  s_add_u32 s43, s43, s50
  s_mul_i32 s49, s43, 52429
  s_lshr_b32 s49, s49, 19
  s_mul_i32 s49, s49, 10
  s_sub_u32 s43, s43, s49
  s_cmp_ge_u32 s43, 10
  s_cselect_b32 s49, 10, 0
  s_sub_u32 s43, s43, s49
  v_lshrrev_b32 v56, 3, v1
  v_and_b32 v57, 7, v1
  v_lshrrev_b32 v58, 1, v56
  v_xor_b32 v2, v57, v58
  v_xor_b32 v3, 4, v2
  v_lshlrev_b32 v2, 4, v2
  v_lshlrev_b32 v3, 4, v3
  s_movk_i32 s50, 1280
  v_mad_u32_u24 v2, v56, s50, v2
  v_add_u32 v56, 8, v56
  v_mad_u32_u24 v3, v56, s50, v3
  v_add_u32 v4, 20480, v2
  v_add_u32 v5, 20480, v3
  s_lshl_b32 s48, s41, 2
  s_add_u32 s48, s48, s40
  s_mul_i32 s52, s48, 40960
  s_mul_i32 s54, s40, 12288
  s_add_u32 s54, s54, 102400
  s_mul_i32 s47, s40, 1280
  s_mul_i32 s53, s42, 80
  s_lshl_b32 s64, s43, 7
  s_mul_i32 s74, s43, 245760
  s_mul_i32 s48, s40, 80
  s_movk_i32 s50, 3840
  s_mov_b32 s51, 52429
  v_add_u32 v56, s48, v1
  v_mul_u32_u24 v57, s51, v56
  v_lshrrev_b32 v57, 18, v57
  v_mul_u32_u24 v58, 5, v57
  v_sub_u32 v56, v56, v58
  v_and_b32 v58, 0x28, v57
  v_and_b32 v59, 1, v57
  v_lshl_or_b32 v58, v59, 4, v58
  v_bfe_u32 v59, v57, 4, 1
  v_lshl_or_b32 v58, v59, 2, v58
  v_bfe_u32 v59, v57, 1, 2
  v_or_b32 v58, v58, v59
  v_lshlrev_b32 v56, 4, v56
  v_mad_u32_u24 v6, v58, s50, v56
  v_add_u32 v56, s48, v1
  v_add_u32 v56, 64, v56
  v_mul_u32_u24 v57, s51, v56
  v_lshrrev_b32 v57, 18, v57
  v_mul_u32_u24 v58, 5, v57
  v_sub_u32 v56, v56, v58
  v_and_b32 v58, 0x28, v57
  v_and_b32 v59, 1, v57
  v_lshl_or_b32 v58, v59, 4, v58
  v_bfe_u32 v59, v57, 4, 1
  v_lshl_or_b32 v58, v59, 2, v58
  v_bfe_u32 v59, v57, 1, 2
  v_or_b32 v58, v58, v59
  v_lshlrev_b32 v56, 4, v56
  v_mad_u32_u24 v7, v58, s50, v56
  s_waitcnt lgkmcnt(0)
  s_load_dword s61, s[96:97], 1015808
  s_add_u32 s4, s84, s52
  s_addc_u32 s5, s85, 0
  s_and_b32 s5, s5, 0xffff
  s_sub_u32 s6, 2621440, s52
  s_mov_b32 s7, 0x20000
  s_add_u32 s48, s53, 1280
  s_add_u32 s8, s86, s48
  s_addc_u32 s9, s87, 0
  s_and_b32 s9, s9, 0xffff
  s_sub_u32 s10, 2457600, s48
  s_mov_b32 s11, 0x20000
  s_add_u32 m0, s54, 0
  s_nop 0
  buffer_load_dwordx4 v2, s[4:7], s64 offen lds
  s_add_u32 m0, s54, 1024
  s_nop 0
  buffer_load_dwordx4 v3, s[4:7], s64 offen lds
  s_add_u32 m0, s54, 2048
  s_nop 0
  buffer_load_dwordx4 v4, s[4:7], s64 offen lds
  s_add_u32 m0, s54, 3072
  s_nop 0
  buffer_load_dwordx4 v5, s[4:7], s64 offen lds
  s_add_u32 m0, s47, 0
  s_nop 0
  buffer_load_dwordx4 v6, s[8:11], s74 offen lds
  s_add_u32 m0, s47, 1024
  s_mov_b64 exec, 0xffff
  buffer_load_dwordx4 v7, s[8:11], s74 offen lds
  s_mov_b64 exec, -1
  s_add_u32 s65, s64, 128
  s_add_u32 s75, s74, 245760
  s_cmp_eq_u32 s43, 9
  s_cselect_b32 s65, 0, s65
  s_cselect_b32 s75, 0, s75
  s_add_u32 m0, s54, 4096
  s_nop 0
  buffer_load_dwordx4 v2, s[4:7], s65 offen lds
  s_add_u32 m0, s54, 5120
  s_nop 0
  buffer_load_dwordx4 v3, s[4:7], s65 offen lds
  s_add_u32 s66, s65, 128
  s_add_u32 s76, s75, 245760
  s_cmp_eq_u32 s43, 8
  s_cselect_b32 s66, 0, s66
  s_cselect_b32 s76, 0, s76
  s_add_u32 s67, s66, 128
  s_add_u32 s77, s76, 245760
  s_cmp_eq_u32 s43, 7
  s_cselect_b32 s67, 0, s67
  s_cselect_b32 s77, 0, s77
  s_add_u32 s68, s67, 128
  s_add_u32 s78, s77, 245760
  s_cmp_eq_u32 s43, 6
  s_cselect_b32 s68, 0, s68
  s_cselect_b32 s78, 0, s78
  s_add_u32 s69, s68, 128
  s_add_u32 s79, s78, 245760
  s_cmp_eq_u32 s43, 5
  s_cselect_b32 s69, 0, s69
  s_cselect_b32 s79, 0, s79
  s_add_u32 s70, s69, 128
  s_add_u32 s80, s79, 245760
  s_cmp_eq_u32 s43, 4
  s_cselect_b32 s70, 0, s70
  s_cselect_b32 s80, 0, s80
  s_add_u32 s71, s70, 128
  s_add_u32 s81, s80, 245760
  s_cmp_eq_u32 s43, 3
  s_cselect_b32 s71, 0, s71
  s_cselect_b32 s81, 0, s81
  s_add_u32 s72, s71, 128
  s_add_u32 s82, s81, 245760
  s_cmp_eq_u32 s43, 2
  s_cselect_b32 s72, 0, s72
  s_cselect_b32 s82, 0, s82
  s_add_u32 s73, s72, 128
  s_add_u32 s83, s82, 245760
  s_cmp_eq_u32 s43, 1
  s_cselect_b32 s73, 0, s73
  s_cselect_b32 s83, 0, s83
  s_add_u32 s48, s53, 2560
  s_add_u32 s12, s86, s48
  s_addc_u32 s13, s87, 0
  s_and_b32 s13, s13, 0xffff
  s_sub_u32 s14, 2457600, s48
  s_mov_b32 s15, 0x20000
  s_add_u32 s16, s86, s53
  s_addc_u32 s17, s87, 0
  s_and_b32 s17, s17, 0xffff
  s_sub_u32 s18, 2457600, s53
  s_mov_b32 s19, 0x20000
  s_mov_b32 s20, s88
  s_and_b32 s21, s89, 0xffff
  s_mov_b32 s22, 25600
  s_mov_b32 s23, 0x20000
  s_mul_i32 s51, s45, 160
  s_add_u32 s24, s90, s51
  s_addc_u32 s25, s91, 0
  s_and_b32 s25, s25, 0xffff
  s_sub_u32 s26, 819200, s51
  s_mov_b32 s27, 0x20000
  s_mov_b32 s28, s92
  s_and_b32 s29, s93, 0xffff
  s_mov_b32 s30, 2621440
  s_mov_b32 s31, 0x20000
  s_mov_b32 s36, s96
  s_and_b32 s37, s97, 0xffff
  s_mov_b32 s38, 4194304
  s_mov_b32 s39, 0x20000
  s_lshl_b32 s48, s2, 2
  s_add_u32 s48, s48, s40
  s_mul_i32 s48, s48, 19
  v_add_u32 v56, s48, v1
  v_cmp_le_u32 vcc, 6400, v56
  s_nop 1
  v_cndmask_b32 v57, 0, 1, vcc
  s_movk_i32 s49, 12800
  v_cmp_le_u32 vcc, s49, v56
  s_nop 1
  v_cndmask_b32 v57, v57, 2, vcc
  s_movk_i32 s49, 6400
  v_mul_u32_u24 v58, s49, v57
  v_sub_u32 v56, v56, v58
  s_movk_i32 s49, 6554
  v_mul_u32_u24 v58, s49, v56
  v_lshrrev_b32 v58, 16, v58
  v_mul_u32_u24 v59, 10, v58
  v_sub_u32 v59, v56, v59
  v_lshlrev_b32 v59, 7, v59
  s_movk_i32 s49, 3840
  v_mad_u32_u24 v59, v58, s49, v59
  s_movk_i32 s49, 2560
  v_mad_u32_u24 v59, v57, s49, v59
  v_lshlrev_b32 v56, 7, v56
  v_mov_b32 v58, 2130706432
  v_cmp_gt_u32 vcc, 19, v1
  s_nop 1
  s_mov_b64 s[58:59], vcc
  v_cmp_gt_u32 vcc, 2, v57
  s_nop 1
  s_and_b64 vcc, vcc, s[58:59]
  v_cndmask_b32 v59, v58, v59, vcc
  v_cmp_eq_u32 vcc, 2, v57
  s_nop 1
  s_and_b64 vcc, vcc, s[58:59]
  v_cndmask_b32 v56, v58, v56, vcc
  s_mov_b32 s32, s86
  s_and_b32 s33, s87, 0xffff
  s_mov_b32 s34, 2457600
  s_mov_b32 s35, 0x20000
  s_mul_i32 s49, s45, 160
  v_subrev_u32 v238, s49, v56
  s_and_b32 s48, s42, 7
  s_lshr_b32 s49, 0xa5, s48
  s_and_b32 s49, s49, 1
  s_cmp_eq_u32 s49, 0
  s_cbranch_scc1 L_nol2w
  s_cmp_lg_u32 s40, 0
  s_cbranch_scc1 L_nol2w
  s_lshr_b32 s49, s48, 1
  s_lshr_b32 s50, s42, 3
  s_lshl_b32 s50, s50, 2
  s_add_u32 s49, s49, s50
  s_lshl_b32 s50, s41, 3
  s_add_u32 s49, s49, s50
  s_mul_i32 s49, s49, 20
  v_add_u32 v56, s49, v1
  s_movk_i32 s49, 1639
  v_mul_u32_u24 v57, s49, v56
  v_lshrrev_b32 v57, 20, v57
  s_movk_i32 s49, 640
  v_mul_u32_u24 v58, s49, v57
  v_sub_u32 v56, v56, v58
  s_movk_i32 s49, 3840
  v_mul_u32_u24 v56, s49, v56
  v_and_b32 v58, 1, v57
  s_movk_i32 s49, 640
  v_mad_u32_u24 v56, v58, s49, v56
  v_lshrrev_b32 v58, 1, v57
  s_movk_i32 s49, 2560
  v_mad_u32_u24 v56, v58, s49, v56
  v_add_u32 v56, 256, v56
  v_mov_b32 v57, 2130706432
  v_cmp_gt_u32 vcc, 20, v1
  s_nop 1
  v_cndmask_b32 v56, v57, v56, vcc
  s_mov_b32 s32, s86
  s_and_b32 s33, s87, 0xffff
  s_mov_b32 s34, 2457600
  s_mov_b32 s35, 0x20000
  buffer_load_dword v55, v56, s[32:35], 0 offen
L_nol2w:
  v_lshrrev_b32 v22, 4, v1
  v_and_b32 v23, 15, v1
  v_lshrrev_b32 v56, 1, v23
  v_xor_b32 v56, v56, v22
  v_lshlrev_b32 v56, 4, v56
  v_lshl_add_u32 v56, v23, 7, v56
  v_add_u32 v16, s54, v56
  v_xor_b32 v56, 64, v56
  v_add_u32 v17, s54, v56
  v_bfe_u32 v56, v1, 2, 2
  v_and_b32 v57, 1, v22
  v_lshl_add_u32 v56, v57, 2, v56
  v_lshrrev_b32 v57, 1, v22
  v_lshl_add_u32 v56, v56, 1, v57
  v_mul_u32_u24 v56, 80, v56
  v_and_b32 v57, 3, v1
  v_and_b32 v58, 1, v57
  v_lshrrev_b32 v59, 1, v57
  v_mul_u32_u24 v59, 5, v59
  v_lshl_add_u32 v59, v58, 1, v59
  v_lshl_add_u32 v18, v59, 3, v56
  v_xor_b32 v58, 1, v58
  v_lshl_add_u32 v19, v58, 5, v18
  v_lshl_add_u32 v20, v57, 3, v56
  v_add_u32 v20, 51200, v20
  v_add_u32 v21, 51200, v19
  s_mov_b32 s55, 0x3fb8aa3b
  s_getreg_b32 s57, hwreg(HW_REG_XCC_ID, 0, 4)
  s_waitcnt lgkmcnt(0)
  s_mul_i32 s61, s61, 0x9e3779b1
  s_add_u32 s61, s61, 0x7f4a7c15
  s_and_b32 s62, s61, 0xfffffff0
  s_or_b32 s57, s57, s62
  s_mul_i32 s51, s40, 5120
  s_add_u32 s51, s51, 102400
  v_and_b32 v56, 1, v22
  v_lshl_add_u32 v56, v56, 4, v23
  v_mul_u32_u24 v56, 160, v56
  v_lshrrev_b32 v57, 1, v22
  v_mul_u32_u24 v57, 80, v57
  v_add3_u32 v24, v56, v57, s51
  s_lshr_b32 s50, s40, 1
  s_mul_i32 s51, s50, 80
  s_add_u32 s51, s51, 102400
  v_bfe_u32 v56, v1, 2, 2
  v_lshl_add_u32 v56, v22, 2, v56
  v_mul_u32_u24 v56, 160, v56
  v_and_b32 v57, 3, v1
  v_lshl_add_u32 v56, v57, 3, v56
  v_add_u32 v25, s51, v56
  v_lshlrev_b32 v56, 4, v1
  s_mul_i32 s51, s40, 3072
  s_add_u32 s51, s51, 122880
  v_add_u32 v10, s51, v56
  s_and_b32 s49, s40, 1
  s_cmp_eq_u32 s49, 1
  s_cselect_b32 s51, 2, s50
  s_lshl_b32 s51, s51, 10
  s_add_u32 s51, s51, 122880
  v_add_u32 v11, s51, v56
  v_and_b32 v57, 3, v23
  v_add_u32 v57, 16, v57
  v_cmp_eq_u32 vcc, 4, v23
  s_nop 1
  v_cndmask_b32 v57, v57, 20, vcc
  s_mov_b64 s[58:59], vcc
  v_lshrrev_b32 v58, 2, v23
  s_lshl_b32 s51, s50, 1
  v_cmp_eq_u32 vcc, s51, v58
  s_nop 1
  s_or_b64 s[58:59], s[58:59], vcc
  s_cmp_eq_u32 s49, 1
  s_cselect_b64 s[58:59], s[58:59], -1
  s_cselect_b32 s52, 1, 0
  v_cmp_eq_u32 vcc, 1, s52
  s_nop 1
  v_cndmask_b32 v57, v23, v57, vcc
  s_mul_i32 s51, s50, 21
  v_add_u32 v57, s51, v57
  s_add_u32 m0, s54, 6144
  v_mul_u32_u24 v57, 80, v57
  buffer_load_dwordx4 v4, s[4:7], s65 offen lds
  v_lshl_add_u32 v57, v22, 3, v57
  v_add_u32 v57, 157696, v57
  v_lshlrev_b32 v58, 3, v1
  v_add_u32 v58, 161792, v58
  v_cndmask_b32 v12, v58, v57, s[58:59]
  v_cmp_gt_u32 vcc, 2, v22
  s_nop 1
  v_cndmask_b32 v13, v58, v12, vcc
  v_lshlrev_b32 v56, 4, v0
  v_add_u32 v14, 157696, v56
  v_mov_b32 v57, 161792
  v_cmp_gt_u32 vcc, 224, v0
  s_nop 1
  v_cndmask_b32 v14, v57, v14, vcc
  s_mul_i32 s48, s42, 57344
  s_lshl_b32 s49, s40, 8
  s_add_u32 s50, s48, s49
  v_mul_u32_u24 v56, 3584, v22
  v_lshl_add_u32 v56, v23, 4, v56
  v_add_u32 v29, s50, v56
  v_lshrrev_b32 v56, 2, v1
  v_mul_u32_u24 v56, 3584, v56
  v_and_b32 v57, 3, v1
  v_lshl_add_u32 v56, v57, 10, v56
  v_add_u32 v47, s48, v56
  v_and_b32 v56, 1, v23
  v_mov_b32 v57, 0x3f80
  v_lshlrev_b32 v56, 4, v56
  v_lshlrev_b32 v57, v56, v57
  v_lshrrev_b32 v56, 1, v23
  v_cmp_eq_u32 vcc, 0, v56
  s_nop 1
  v_cndmask_b32 v32, 0, v57, vcc
  v_cmp_eq_u32 vcc, 1, v56
  s_nop 1
  v_cndmask_b32 v33, 0, v57, vcc
  v_cmp_eq_u32 vcc, 2, v56
  s_add_u32 m0, s54, 7168
  s_nop 0
  v_cndmask_b32 v34, 0, v57, vcc
  buffer_load_dwordx4 v5, s[4:7], s65 offen lds
  v_cmp_eq_u32 vcc, 3, v56
  s_nop 1
  v_cndmask_b32 v35, 0, v57, vcc
  v_lshlrev_b32 v56, 4, v23
  v_lshl_add_u32 v56, v22, 3, v56
  s_add_u32 s49, s49, 157696
  v_add_u32 v31, s49, v56
  v_lshrrev_b32 v56, 2, v23
  v_cmp_eq_u32 s[0:1], 1, v56
  v_lshlrev_b32 v30, 4, v1
  v_add_u32 v30, 983040, v30
  v_lshrrev_b32 v56, 1, v22
  v_mul_u32_u24 v57, 1680, v56
  v_and_b32 v58, 3, v23
  v_mul_u32_u24 v58, 80, v58
  v_add_u32 v57, v57, v58
  v_add_u32 v57, 157696, v57
  v_mul_u32_u24 v58, 320, v56
  v_add_u32 v36, v57, v58
  v_xor_b32 v58, 1, v56
  v_mul_u32_u24 v58, 1280, v58
  v_add_u32 v37, v57, v58
  v_add_u32 v38, 1600, v57
  v_lshrrev_b32 v58, 2, v23
  v_cmp_eq_u32 vcc, v58, v22
  v_mov_b32 v59, 155648
  s_nop 0
  v_cndmask_b32 v36, v59, v36, vcc
  v_cndmask_b32 v37, v59, v37, vcc
  v_cndmask_b32 v38, v59, v38, vcc
  s_lshl_b32 s48, s41, 3
  s_lshl_b32 s49, s40, 1
  s_add_u32 s48, s48, s49
  s_mul_i32 s48, s48, 20480
  s_mul_i32 s49, s42, 1280
  s_add_u32 s48, s48, s49
  s_add_u32 m0, s47, 5120
  s_nop 0
  buffer_load_dwordx4 v6, s[8:11], s75 offen lds
  s_add_u32 s48, s48, 1048576
  v_and_b32 v57, 1, v22
  s_movk_i32 s50, 0x5000
  v_mul_u32_u24 v57, s50, v57
  v_lshl_add_u32 v57, v23, 4, v57
  v_add_u32 v57, s48, v57
  v_mul_u32_u24 v58, 768, v56
  v_add_u32 v39, v57, v58
  v_add_u32 v40, 512, v57
  v_mov_b32 v58, 2130706432
  v_cmp_gt_u32 vcc, 32, v1
  s_nop 1
  v_cndmask_b32 v40, v58, v40, vcc
  v_bfe_u32 v56, v1, 2, 2
  v_lshl_add_u32 v56, v22, 2, v56
  v_mul_u32_u24 v56, 160, v56
  v_and_b32 v57, 3, v1
  v_mul_u32_u24 v57, 40, v57
  v_add_u32 v56, v56, v57
  v_add_u32 v41, 51200, v56
  v_add_u32 v44, 102400, v56
  s_lshl_b32 s48, s44, 2
  s_add_u32 s49, s48, s40
  s_mul_i32 s48, s49, 20480
  s_add_u32 s48, s48, 1048576
  v_lshlrev_b32 v56, 4, v1
  v_add_u32 v42, s48, v56
  s_lshr_b32 s48, s49, 3
  s_lshl_b32 s52, s48, 4
  v_and_b32 v57, 15, v1
  v_add_u32 v57, s52, v57
  v_lshlrev_b32 v57, 4, v57
  s_and_b32 s48, s49, 7
  s_lshr_b32 s48, s48, 1
  s_lshl_b32 s48, s48, 2
  s_add_u32 m0, s47, 6144
  s_mov_b64 exec, 0xffff
  buffer_load_dwordx4 v7, s[8:11], s75 offen lds
  s_mov_b64 exec, -1
  s_add_u32 s48, s48, 987136
  v_add_u32 v48, s48, v57
  s_lshl_b32 s49, s49, 4
  v_add_u32 v56, s49, v23
  s_movk_i32 s50, 1280
  v_mul_u32_u24 v56, s50, v56
  v_mul_u32_u24 v57, 40, v22
  s_mul_i32 s48, s45, 160
  v_add3_u32 v46, v56, v57, s48
  v_lshrrev_b32 v56, 1, v1
  v_add_u32 v56, s49, v56
  v_mul_u32_u24 v56, s50, v56
  s_and_b32 s48, s48, 0xffffff80
  v_and_b32 v57, 1, v1
  v_lshlrev_b32 v57, 7, v57
  v_add3_u32 v56, v56, v57, s48
  v_mov_b32 v57, 2130706432
  v_cmp_gt_u32 vcc, 32, v1
  s_nop 1
  v_cndmask_b32 v239, v57, v56, vcc
  s_lshl_b32 s48, s41, 4
  s_add_u32 s48, s48, s42
  s_lshl_b32 s48, s48, 2
  s_add_u32 s48, s48, s40
  s_lshl_b32 s48, s48, 2
  s_add_u32 s48, s48, 987136
  v_mov_b32 v240, s48
  v_mov_b32 v241, s62
  s_movk_i32 s50, 1280
  s_mov_b32 s51, 52429
  v_add_u32 v56, 0, v1
  v_lshrrev_b32 v57, 1, v56
  v_mul_u32_u24 v57, s51, v57
  s_add_u32 m0, s54, 8192
  v_lshrrev_b32 v57, 18, v57
  buffer_load_dwordx4 v2, s[4:7], s66 offen lds
  v_mul_u32_u24 v58, 10, v57
  v_sub_u32 v56, v56, v58
  v_and_b32 v58, 12, v57
  v_lshlrev_b32 v58, 1, v58
  v_lshrrev_b32 v59, 4, v57
  v_lshl_or_b32 v58, v59, 2, v58
  v_and_b32 v59, 3, v57
  v_or_b32 v58, v58, v59
  v_lshlrev_b32 v56, 4, v56
  v_mad_u32_u24 v8, v58, s50, v56
  v_add_u32 v56, 64, v1
  v_lshrrev_b32 v57, 1, v56
  v_mul_u32_u24 v57, s51, v57
  v_lshrrev_b32 v57, 18, v57
  v_mul_u32_u24 v58, 10, v57
  v_sub_u32 v56, v56, v58
  v_and_b32 v58, 12, v57
  v_lshlrev_b32 v58, 1, v58
  v_lshrrev_b32 v59, 4, v57
  v_lshl_or_b32 v58, v59, 2, v58
  v_and_b32 v59, 3, v57
  v_or_b32 v58, v58, v59
  v_lshlrev_b32 v56, 4, v56
  v_mad_u32_u24 v9, v58, s50, v56
  v_add_u32 v56, 128, v1
  v_lshrrev_b32 v57, 1, v56
  v_mul_u32_u24 v57, s51, v57
  v_lshrrev_b32 v57, 18, v57
  v_mul_u32_u24 v58, 10, v57
  v_sub_u32 v56, v56, v58
  v_and_b32 v58, 12, v57
  v_lshlrev_b32 v58, 1, v58
  v_lshrrev_b32 v59, 4, v57
  s_add_u32 m0, s54, 9216
  v_lshl_or_b32 v58, v59, 2, v58
  buffer_load_dwordx4 v3, s[4:7], s66 offen lds
  v_and_b32 v59, 3, v57
  v_or_b32 v58, v58, v59
  v_lshlrev_b32 v56, 4, v56
  v_mad_u32_u24 v49, v58, s50, v56
  v_add_u32 v56, 192, v1
  v_lshrrev_b32 v57, 1, v56
  v_mul_u32_u24 v57, s51, v57
  v_lshrrev_b32 v57, 18, v57
  v_mul_u32_u24 v58, 10, v57
  v_sub_u32 v56, v56, v58
  v_and_b32 v58, 12, v57
  v_lshlrev_b32 v58, 1, v58
  v_lshrrev_b32 v59, 4, v57
  v_lshl_or_b32 v58, v59, 2, v58
  v_and_b32 v59, 3, v57
  v_or_b32 v58, v58, v59
  v_lshlrev_b32 v56, 4, v56
  v_mad_u32_u24 v51, v58, s50, v56
  v_add_u32 v56, 256, v1
  v_lshrrev_b32 v57, 1, v56
  v_mul_u32_u24 v57, s51, v57
  v_lshrrev_b32 v57, 18, v57
  v_mul_u32_u24 v58, 10, v57
  v_sub_u32 v56, v56, v58
  v_and_b32 v58, 12, v57
  v_lshlrev_b32 v58, 1, v58
  v_lshrrev_b32 v59, 4, v57
  v_lshl_or_b32 v58, v59, 2, v58
  v_and_b32 v59, 3, v57
  v_or_b32 v58, v58, v59
  v_lshlrev_b32 v56, 4, v56
  v_mad_u32_u24 v253, v58, s50, v56
  s_movk_i32 s50, 3840
  s_add_u32 m0, s54, 10240
  v_add_u32 v56, 0, v1
  buffer_load_dwordx4 v4, s[4:7], s66 offen lds
  v_mul_u32_u24 v57, s51, v56
  v_lshrrev_b32 v57, 18, v57
  v_mul_u32_u24 v58, 5, v57
  v_sub_u32 v56, v56, v58
  v_and_b32 v58, 0x28, v57
  v_and_b32 v59, 1, v57
  v_lshl_or_b32 v58, v59, 4, v58
  v_bfe_u32 v59, v57, 4, 1
  v_lshl_or_b32 v58, v59, 2, v58
  v_bfe_u32 v59, v57, 1, 2
  v_or_b32 v58, v58, v59
  v_lshlrev_b32 v56, 4, v56
  v_mad_u32_u24 v248, v58, s50, v56
  v_add_u32 v56, 64, v1
  v_mul_u32_u24 v57, s51, v56
  v_lshrrev_b32 v57, 18, v57
  v_mul_u32_u24 v58, 5, v57
  v_sub_u32 v56, v56, v58
  v_and_b32 v58, 0x28, v57
  v_and_b32 v59, 1, v57
  v_lshl_or_b32 v58, v59, 4, v58
  v_bfe_u32 v59, v57, 4, 1
  v_lshl_or_b32 v58, v59, 2, v58
  v_bfe_u32 v59, v57, 1, 2
  v_or_b32 v58, v58, v59
  v_lshlrev_b32 v56, 4, v56
  v_mad_u32_u24 v249, v58, s50, v56
  v_add_u32 v56, 128, v1
  v_mul_u32_u24 v57, s51, v56
  v_lshrrev_b32 v57, 18, v57
  v_mul_u32_u24 v58, 5, v57
  v_sub_u32 v56, v56, v58
  v_and_b32 v58, 0x28, v57
  s_add_u32 m0, s54, 11264
  v_and_b32 v59, 1, v57
  buffer_load_dwordx4 v5, s[4:7], s66 offen lds
  v_lshl_or_b32 v58, v59, 4, v58
  v_bfe_u32 v59, v57, 4, 1
  v_lshl_or_b32 v58, v59, 2, v58
  v_bfe_u32 v59, v57, 1, 2
  v_or_b32 v58, v58, v59
  v_lshlrev_b32 v56, 4, v56
  v_mad_u32_u24 v250, v58, s50, v56
  v_add_u32 v56, 192, v1
  v_mul_u32_u24 v57, s51, v56
  v_lshrrev_b32 v57, 18, v57
  v_mul_u32_u24 v58, 5, v57
  v_sub_u32 v56, v56, v58
  v_and_b32 v58, 0x28, v57
  v_and_b32 v59, 1, v57
  v_lshl_or_b32 v58, v59, 4, v58
  v_bfe_u32 v59, v57, 4, 1
  v_lshl_or_b32 v58, v59, 2, v58
  v_bfe_u32 v59, v57, 1, 2
  v_or_b32 v58, v58, v59
  v_lshlrev_b32 v56, 4, v56
  v_mad_u32_u24 v251, v58, s50, v56
  v_add_u32 v56, 256, v1
  v_mul_u32_u24 v57, s51, v56
  v_lshrrev_b32 v57, 18, v57
  v_mul_u32_u24 v58, 5, v57
  v_sub_u32 v56, v56, v58
  v_and_b32 v58, 0x28, v57
  v_and_b32 v59, 1, v57
  v_lshl_or_b32 v58, v59, 4, v58
  v_bfe_u32 v59, v57, 4, 1
  v_lshl_or_b32 v58, v59, 2, v58
  v_bfe_u32 v59, v57, 1, 2
  v_or_b32 v58, v58, v59
  s_add_u32 m0, s47, 10240
  v_lshlrev_b32 v56, 4, v56
  buffer_load_dwordx4 v6, s[8:11], s76 offen lds
  v_mad_u32_u24 v252, v58, s50, v56
  s_mul_i32 s60, s40, 5120
  s_add_u32 s48, s40, s43
  s_cmp_ge_u32 s48, 10
  s_cselect_b32 s49, 10, 0
  s_sub_u32 s48, s48, s49
  s_mul_i32 s33, s48, 245760
  s_add_u32 s48, s40, s43
  s_add_u32 s48, s48, 4
  s_cmp_ge_u32 s48, 10
  s_cselect_b32 s49, 10, 0
  s_sub_u32 s48, s48, s49
  s_mul_i32 s34, s48, 245760
  s_add_u32 s48, s40, s43
  s_add_u32 s48, s48, 8
  s_cmp_ge_u32 s48, 10
  s_cselect_b32 s49, 10, 0
  s_sub_u32 s48, s48, s49
  s_mul_i32 s35, s48, 245760
  s_lshl_b32 s48, s42, 4
  s_add_u32 s48, s48, s41
  s_mul_i32 s48, s48, 3584
  v_lshlrev_b32 v56, 4, v0
  v_add_u32 v28, s48, v56
  v_mov_b32 v57, 2130706432
  v_cmp_gt_u32 vcc, 224, v0
  s_nop 1
  v_cndmask_b32 v28, v57, v28, vcc
  v_mov_b32 v244, -1
  v_mov_b32 v245, -1
  v_mov_b32 v246, -1
  v_mov_b32 v247, -1
  s_mul_i32 s48, s40, 20
  v_add_u32 v56, s48, v1
  s_movk_i32 s49, 6554
  s_add_u32 m0, s47, 11264
  s_mov_b64 exec, 0xffff
  buffer_load_dwordx4 v7, s[8:11], s76 offen lds
  s_mov_b64 exec, -1
  v_mul_u32_u24 v57, s49, v56
  v_lshrrev_b32 v57, 16, v57
  v_mul_u32_u24 v58, 10, v57
  v_sub_u32 v58, v56, v58
  v_lshlrev_b32 v58, 7, v58
  s_movk_i32 s50, 0x5000
  v_mad_u32_u24 v57, v57, s50, v58
  s_lshl_b32 s48, s41, 3
  s_mul_i32 s48, s48, 20480
  s_mul_i32 s49, s42, 1280
  s_add_u32 s48, s48, s49
  s_add_u32 s48, s48, 1048576
  v_add_u32 v57, s48, v57
  v_mov_b32 v58, 2130706432
  v_cmp_gt_u32 vcc, 20, v1
  s_nop 1
  v_cndmask_b32 v242, v58, v57, vcc
  v_lshlrev_b32 v56, 4, v1
  s_mul_i32 s48, s42, 1600
  s_lshl_b32 s49, s40, 10
  s_add_u32 s48, s48, s49
  s_cmp_ge_u32 s40, 2
  s_cselect_b32 s48, 0x100000, s48
  s_add_u32 m0, s49, 153600
  v_add_u32 v56, s48, v56
  buffer_load_dwordx4 v56, s[20:23], 0 offen lds
  buffer_store_dwordx4 v[244:247], v28, s[36:39], 0 offen sc1
  s_waitcnt vmcnt(14)
  s_barrier
  ds_read_b128 a[0:3], v16 offset:0
  ds_read_b128 a[4:7], v16 offset:2048
  ds_read_b64_tr_b16 v[88:89], v18 offset:0
  ds_read_b64_tr_b16 v[90:91], v18 offset:1280
  ds_read_b64_tr_b16 v[92:93], v18 offset:8
  ds_read_b64_tr_b16 v[94:95], v18 offset:1288
  ds_read_b64_tr_b16 v[96:97], v19 offset:0
  ds_read_b64_tr_b16 v[98:99], v19 offset:1280
  ds_read_b128 a[8:11], v17 offset:0
  ds_read_b128 a[12:15], v17 offset:2048
  ds_read_b64_tr_b16 v[100:101], v18 offset:2560
  ds_read_b64_tr_b16 v[102:103], v18 offset:3840
  ds_read_b64_tr_b16 v[104:105], v18 offset:2568
  ds_read_b64_tr_b16 v[106:107], v18 offset:3848
  ds_read_b64_tr_b16 v[108:109], v19 offset:2560
  ds_read_b64_tr_b16 v[110:111], v19 offset:3840
  s_waitcnt vmcnt(8)
  s_barrier
  s_waitcnt lgkmcnt(0)
  v_mfma_f32_16x16x32_bf16 v[64:67], v[88:91], a[0:3], 0
  ds_read_b128 a[16:19], v16 offset:4096
  ds_read_b128 a[20:23], v16 offset:6144
  v_mfma_f32_16x16x32_bf16 v[76:79], v[88:91], a[4:7], 0
  ds_read_b64_tr_b16 v[112:113], v18 offset:5120
  s_add_u32 m0, s54, 0
  ds_read_b64_tr_b16 v[114:115], v18 offset:6400
  buffer_load_dwordx4 v2, s[4:7], s67 offen lds
  v_mfma_f32_16x16x32_bf16 v[68:71], v[92:95], a[0:3], 0
  ds_read_b64_tr_b16 v[116:117], v18 offset:5128
  ds_read_b64_tr_b16 v[118:119], v18 offset:6408
  v_mfma_f32_16x16x32_bf16 v[80:83], v[92:95], a[4:7], 0
  ds_read_b64_tr_b16 v[120:121], v19 offset:5120
  s_add_u32 m0, s54, 1024
  ds_read_b64_tr_b16 v[122:123], v19 offset:6400
  buffer_load_dwordx4 v3, s[4:7], s67 offen lds
  v_mfma_f32_16x16x32_bf16 v[72:75], v[96:99], a[0:3], 0
  ds_read_b128 a[24:27], v17 offset:4096
  v_mfma_f32_16x16x32_bf16 v[84:87], v[96:99], a[4:7], 0
  s_add_u32 m0, s54, 2048
  ds_read_b128 a[28:31], v17 offset:6144
  buffer_load_dwordx4 v4, s[4:7], s67 offen lds
  v_mfma_f32_16x16x32_bf16 v[64:67], v[100:103], a[8:11], v[64:67]
  ds_read_b64_tr_b16 v[124:125], v18 offset:7680
  v_mfma_f32_16x16x32_bf16 v[76:79], v[100:103], a[12:15], v[76:79]
  s_add_u32 m0, s54, 3072
  ds_read_b64_tr_b16 v[126:127], v18 offset:8960
  buffer_load_dwordx4 v5, s[4:7], s67 offen lds
  v_mfma_f32_16x16x32_bf16 v[68:71], v[104:107], a[8:11], v[68:71]
  ds_read_b64_tr_b16 v[128:129], v18 offset:7688
  v_mfma_f32_16x16x32_bf16 v[80:83], v[104:107], a[12:15], v[80:83]
  s_add_u32 m0, s47, 15360
  ds_read_b64_tr_b16 v[130:131], v18 offset:8968
  buffer_load_dwordx4 v6, s[8:11], s77 offen lds
  v_mfma_f32_16x16x32_bf16 v[72:75], v[108:111], a[8:11], v[72:75]
  ds_read_b64_tr_b16 v[132:133], v19 offset:7680
  v_mfma_f32_16x16x32_bf16 v[84:87], v[108:111], a[12:15], v[84:87]
  ds_read_b64_tr_b16 v[134:135], v19 offset:8960
  s_add_u32 m0, s47, 16384
  s_mov_b64 exec, 0xffff
  buffer_load_dwordx4 v7, s[8:11], s77 offen lds
  s_mov_b64 exec, -1
  s_waitcnt vmcnt(8)
  s_barrier
  s_waitcnt lgkmcnt(0)
  v_mfma_f32_16x16x32_bf16 v[64:67], v[112:115], a[16:19], v[64:67]
  ds_read_b128 a[32:35], v16 offset:8192
  ds_read_b128 a[36:39], v16 offset:10240
  v_mfma_f32_16x16x32_bf16 v[76:79], v[112:115], a[20:23], v[76:79]
  ds_read_b64_tr_b16 v[88:89], v18 offset:10240
  s_add_u32 m0, s54, 4096
  ds_read_b64_tr_b16 v[90:91], v18 offset:11520
  buffer_load_dwordx4 v2, s[4:7], s68 offen lds
  v_mfma_f32_16x16x32_bf16 v[68:71], v[116:119], a[16:19], v[68:71]
  ds_read_b64_tr_b16 v[92:93], v18 offset:10248
  ds_read_b64_tr_b16 v[94:95], v18 offset:11528
  v_mfma_f32_16x16x32_bf16 v[80:83], v[116:119], a[20:23], v[80:83]
  ds_read_b64_tr_b16 v[96:97], v19 offset:10240
  s_add_u32 m0, s54, 5120
  ds_read_b64_tr_b16 v[98:99], v19 offset:11520
  buffer_load_dwordx4 v3, s[4:7], s68 offen lds
  v_mfma_f32_16x16x32_bf16 v[72:75], v[120:123], a[16:19], v[72:75]
  ds_read_b128 a[40:43], v17 offset:8192
  v_mfma_f32_16x16x32_bf16 v[84:87], v[120:123], a[20:23], v[84:87]
  s_add_u32 m0, s54, 6144
  ds_read_b128 a[44:47], v17 offset:10240
  buffer_load_dwordx4 v4, s[4:7], s68 offen lds
  v_mfma_f32_16x16x32_bf16 v[64:67], v[124:127], a[24:27], v[64:67]
  ds_read_b64_tr_b16 v[100:101], v18 offset:12800
  v_mfma_f32_16x16x32_bf16 v[76:79], v[124:127], a[28:31], v[76:79]
  s_add_u32 m0, s54, 7168
  ds_read_b64_tr_b16 v[102:103], v18 offset:14080
  buffer_load_dwordx4 v5, s[4:7], s68 offen lds
  v_mfma_f32_16x16x32_bf16 v[68:71], v[128:131], a[24:27], v[68:71]
  ds_read_b64_tr_b16 v[104:105], v18 offset:12808
  v_mfma_f32_16x16x32_bf16 v[80:83], v[128:131], a[28:31], v[80:83]
  s_add_u32 m0, s47, 20480
  ds_read_b64_tr_b16 v[106:107], v18 offset:14088
  buffer_load_dwordx4 v6, s[8:11], s78 offen lds
  v_mfma_f32_16x16x32_bf16 v[72:75], v[132:135], a[24:27], v[72:75]
  ds_read_b64_tr_b16 v[108:109], v19 offset:12800
  v_mfma_f32_16x16x32_bf16 v[84:87], v[132:135], a[28:31], v[84:87]
  ds_read_b64_tr_b16 v[110:111], v19 offset:14080
  s_add_u32 m0, s47, 21504
  s_mov_b64 exec, 0xffff
  buffer_load_dwordx4 v7, s[8:11], s78 offen lds
  s_mov_b64 exec, -1
  s_waitcnt vmcnt(6)
  s_barrier
  s_waitcnt lgkmcnt(0)
  v_mfma_f32_16x16x32_bf16 v[64:67], v[88:91], a[32:35], v[64:67]
  ds_read_b128 a[48:51], v16 offset:0
  ds_read_b128 a[52:55], v16 offset:2048
  v_mfma_f32_16x16x32_bf16 v[76:79], v[88:91], a[36:39], v[76:79]
  ds_read_b64_tr_b16 v[112:113], v18 offset:15360
  s_add_u32 m0, s54, 8192
  ds_read_b64_tr_b16 v[114:115], v18 offset:16640
  buffer_load_dwordx4 v2, s[4:7], s69 offen lds
  v_mfma_f32_16x16x32_bf16 v[68:71], v[92:95], a[32:35], v[68:71]
  ds_read_b64_tr_b16 v[116:117], v18 offset:15368
  ds_read_b64_tr_b16 v[118:119], v18 offset:16648
  v_mfma_f32_16x16x32_bf16 v[80:83], v[92:95], a[36:39], v[80:83]
  ds_read_b64_tr_b16 v[120:121], v19 offset:15360
  s_add_u32 m0, s54, 9216
  ds_read_b64_tr_b16 v[122:123], v19 offset:16640
  buffer_load_dwordx4 v3, s[4:7], s69 offen lds
  v_mfma_f32_16x16x32_bf16 v[72:75], v[96:99], a[32:35], v[72:75]
  ds_read_b128 a[56:59], v17 offset:0
  v_mfma_f32_16x16x32_bf16 v[84:87], v[96:99], a[36:39], v[84:87]
  s_add_u32 m0, s54, 10240
  ds_read_b128 a[60:63], v17 offset:2048
  buffer_load_dwordx4 v4, s[4:7], s69 offen lds
  v_mfma_f32_16x16x32_bf16 v[64:67], v[100:103], a[40:43], v[64:67]
  ds_read_b64_tr_b16 v[124:125], v18 offset:17920
  v_mfma_f32_16x16x32_bf16 v[76:79], v[100:103], a[44:47], v[76:79]
  s_add_u32 m0, s54, 11264
  ds_read_b64_tr_b16 v[126:127], v18 offset:19200
  buffer_load_dwordx4 v5, s[4:7], s69 offen lds
  v_mfma_f32_16x16x32_bf16 v[68:71], v[104:107], a[40:43], v[68:71]
  ds_read_b64_tr_b16 v[128:129], v18 offset:17928
  v_mfma_f32_16x16x32_bf16 v[80:83], v[104:107], a[44:47], v[80:83]
  s_add_u32 m0, s47, 25600
  ds_read_b64_tr_b16 v[130:131], v18 offset:19208
  buffer_load_dwordx4 v6, s[8:11], s79 offen lds
  v_mfma_f32_16x16x32_bf16 v[72:75], v[108:111], a[40:43], v[72:75]
  ds_read_b64_tr_b16 v[132:133], v19 offset:17920
  v_mfma_f32_16x16x32_bf16 v[84:87], v[108:111], a[44:47], v[84:87]
  ds_read_b64_tr_b16 v[134:135], v19 offset:19200
  s_add_u32 m0, s47, 26624
  s_mov_b64 exec, 0xffff
  buffer_load_dwordx4 v7, s[8:11], s79 offen lds
  s_mov_b64 exec, -1
  s_waitcnt vmcnt(6)
  s_barrier
  s_waitcnt lgkmcnt(0)
  v_mfma_f32_16x16x32_bf16 v[64:67], v[112:115], a[48:51], v[64:67]
  ds_read_b128 a[64:67], v16 offset:4096
  ds_read_b128 a[68:71], v16 offset:6144
  v_mfma_f32_16x16x32_bf16 v[76:79], v[112:115], a[52:55], v[76:79]
  ds_read_b64_tr_b16 v[88:89], v18 offset:20480
  s_add_u32 m0, s54, 0
  ds_read_b64_tr_b16 v[90:91], v18 offset:21760
  buffer_load_dwordx4 v2, s[4:7], s70 offen lds
  v_mfma_f32_16x16x32_bf16 v[68:71], v[116:119], a[48:51], v[68:71]
  ds_read_b64_tr_b16 v[92:93], v18 offset:20488
  ds_read_b64_tr_b16 v[94:95], v18 offset:21768
  v_mfma_f32_16x16x32_bf16 v[80:83], v[116:119], a[52:55], v[80:83]
  ds_read_b64_tr_b16 v[96:97], v19 offset:20480
  s_add_u32 m0, s54, 1024
  ds_read_b64_tr_b16 v[98:99], v19 offset:21760
  buffer_load_dwordx4 v3, s[4:7], s70 offen lds
  v_mfma_f32_16x16x32_bf16 v[72:75], v[120:123], a[48:51], v[72:75]
  ds_read_b128 a[72:75], v17 offset:4096
  v_mfma_f32_16x16x32_bf16 v[84:87], v[120:123], a[52:55], v[84:87]
  s_add_u32 m0, s54, 2048
  ds_read_b128 a[76:79], v17 offset:6144
  buffer_load_dwordx4 v4, s[4:7], s70 offen lds
  v_mfma_f32_16x16x32_bf16 v[64:67], v[124:127], a[56:59], v[64:67]
  ds_read_b64_tr_b16 v[100:101], v18 offset:23040
  v_mfma_f32_16x16x32_bf16 v[76:79], v[124:127], a[60:63], v[76:79]
  s_add_u32 m0, s54, 3072
  ds_read_b64_tr_b16 v[102:103], v18 offset:24320
  buffer_load_dwordx4 v5, s[4:7], s70 offen lds
  v_mfma_f32_16x16x32_bf16 v[68:71], v[128:131], a[56:59], v[68:71]
  ds_read_b64_tr_b16 v[104:105], v18 offset:23048
  v_mfma_f32_16x16x32_bf16 v[80:83], v[128:131], a[60:63], v[80:83]
  s_add_u32 m0, s47, 30720
  ds_read_b64_tr_b16 v[106:107], v18 offset:24328
  buffer_load_dwordx4 v6, s[8:11], s80 offen lds
  v_mfma_f32_16x16x32_bf16 v[72:75], v[132:135], a[56:59], v[72:75]
  ds_read_b64_tr_b16 v[108:109], v19 offset:23040
  v_mfma_f32_16x16x32_bf16 v[84:87], v[132:135], a[60:63], v[84:87]
  ds_read_b64_tr_b16 v[110:111], v19 offset:24320
  s_add_u32 m0, s47, 31744
  s_mov_b64 exec, 0xffff
  buffer_load_dwordx4 v7, s[8:11], s80 offen lds
  s_mov_b64 exec, -1
  v_bfe_u32 v56, v1, 2, 2
  v_and_b32 v57, 3, v1
  v_lshrrev_b32 v58, 1, v22
  v_mul_u32_u24 v59, 800, v58
  v_mul_u32_u24 v56, 40, v56
  v_add_u32 v59, v59, v56
  v_add_u32 v59, 153600, v59
  v_and_b32 v56, 1, v22
  v_mul_u32_u24 v60, 320, v56
  v_add_u32 v60, v60, v59
  v_add_u32 v62, 640, v59
  v_mov_b32 v61, 155648
  v_lshrrev_b32 v59, 1, v57
  v_cmp_eq_u32 s[58:59], v59, v58
  v_and_b32 v59, 1, v57
  v_cmp_eq_u32 s[96:97], 0, v59
  v_cmp_eq_u32 vcc, 0, v56
  s_nop 0
  s_and_b64 s[48:49], s[58:59], s[96:97]
  s_andn2_b64 s[50:51], s[58:59], s[96:97]
  s_and_b64 s[58:59], s[48:49], vcc
  s_and_b64 s[96:97], s[50:51], vcc
  s_nop 1
  v_cndmask_b32 v56, v61, v60, s[50:51]
  v_cndmask_b32 v60, v61, v60, s[48:49]
  v_cndmask_b32 v63, v61, v62, s[96:97]
  v_cndmask_b32 v62, v61, v62, s[58:59]
  v_mov_b32 v61, v56
  ds_read_b64_tr_b16 a[160:161], v60 offset:0
  ds_read_b64_tr_b16 a[162:163], v60 offset:160
  ds_read_b64_tr_b16 a[164:165], v61 offset:0
  ds_read_b64_tr_b16 a[166:167], v61 offset:160
  ds_read_b64_tr_b16 a[168:169], v62 offset:0
  ds_read_b64_tr_b16 a[170:171], v63 offset:0
  ds_read_b64_tr_b16 a[172:173], v60 offset:8
  ds_read_b64_tr_b16 a[174:175], v60 offset:168
  ds_read_b64_tr_b16 a[176:177], v61 offset:8
  ds_read_b64_tr_b16 a[178:179], v61 offset:168
  ds_read_b64_tr_b16 a[180:181], v62 offset:8
  ds_read_b64_tr_b16 a[182:183], v63 offset:8
  ds_read_b64_tr_b16 a[184:185], v60 offset:16
  ds_read_b64_tr_b16 a[186:187], v60 offset:176
  ds_read_b64_tr_b16 a[188:189], v61 offset:16
  ds_read_b64_tr_b16 a[190:191], v61 offset:176
  ds_read_b64_tr_b16 a[192:193], v62 offset:16
  ds_read_b64_tr_b16 a[194:195], v63 offset:16
  ds_read_b64_tr_b16 a[196:197], v60 offset:24
  ds_read_b64_tr_b16 a[198:199], v60 offset:184
  ds_read_b64_tr_b16 a[200:201], v61 offset:24
  ds_read_b64_tr_b16 a[202:203], v61 offset:184
  ds_read_b64_tr_b16 a[204:205], v62 offset:24
  ds_read_b64_tr_b16 a[206:207], v63 offset:24
  ds_read_b64_tr_b16 a[208:209], v60 offset:32
  ds_read_b64_tr_b16 a[210:211], v60 offset:192
  ds_read_b64_tr_b16 a[212:213], v61 offset:32
  ds_read_b64_tr_b16 a[214:215], v61 offset:192
  ds_read_b64_tr_b16 a[216:217], v62 offset:32
  ds_read_b64_tr_b16 a[218:219], v63 offset:32
  s_waitcnt vmcnt(6)
  s_barrier
  s_waitcnt lgkmcnt(15)
  v_mfma_f32_16x16x32_bf16 v[64:67], v[88:91], a[64:67], v[64:67]
  ds_read_b128 a[80:83], v16 offset:8192
  ds_read_b128 a[84:87], v16 offset:10240
  v_mfma_f32_16x16x32_bf16 v[76:79], v[88:91], a[68:71], v[76:79]
  ds_read_b64_tr_b16 v[112:113], v18 offset:25600
  s_add_u32 m0, s54, 4096
  ds_read_b64_tr_b16 v[114:115], v18 offset:26880
  buffer_load_dwordx4 v2, s[4:7], s71 offen lds
  v_mfma_f32_16x16x32_bf16 v[68:71], v[92:95], a[64:67], v[68:71]
  ds_read_b64_tr_b16 v[116:117], v18 offset:25608
  ds_read_b64_tr_b16 v[118:119], v18 offset:26888
  v_mfma_f32_16x16x32_bf16 v[80:83], v[92:95], a[68:71], v[80:83]
  ds_read_b64_tr_b16 v[120:121], v19 offset:25600
  s_add_u32 m0, s54, 5120
  ds_read_b64_tr_b16 v[122:123], v19 offset:26880
  buffer_load_dwordx4 v3, s[4:7], s71 offen lds
  v_mfma_f32_16x16x32_bf16 v[72:75], v[96:99], a[64:67], v[72:75]
  ds_read_b128 a[88:91], v17 offset:8192
  v_mfma_f32_16x16x32_bf16 v[84:87], v[96:99], a[68:71], v[84:87]
  s_add_u32 m0, s54, 6144
  ds_read_b128 a[92:95], v17 offset:10240
  buffer_load_dwordx4 v4, s[4:7], s71 offen lds
  v_mfma_f32_16x16x32_bf16 v[64:67], v[100:103], a[72:75], v[64:67]
  ds_read_b64_tr_b16 v[124:125], v18 offset:28160
  v_mfma_f32_16x16x32_bf16 v[76:79], v[100:103], a[76:79], v[76:79]
  s_add_u32 m0, s54, 7168
  ds_read_b64_tr_b16 v[126:127], v18 offset:29440
  buffer_load_dwordx4 v5, s[4:7], s71 offen lds
  v_mfma_f32_16x16x32_bf16 v[68:71], v[104:107], a[72:75], v[68:71]
  ds_read_b64_tr_b16 v[128:129], v18 offset:28168
  v_mfma_f32_16x16x32_bf16 v[80:83], v[104:107], a[76:79], v[80:83]
  s_add_u32 m0, s47, 35840
  ds_read_b64_tr_b16 v[130:131], v18 offset:29448
  buffer_load_dwordx4 v6, s[8:11], s81 offen lds
  v_mfma_f32_16x16x32_bf16 v[72:75], v[108:111], a[72:75], v[72:75]
  ds_read_b64_tr_b16 v[132:133], v19 offset:28160
  v_mfma_f32_16x16x32_bf16 v[84:87], v[108:111], a[76:79], v[84:87]
  ds_read_b64_tr_b16 v[134:135], v19 offset:29440
  s_add_u32 m0, s47, 36864
  s_mov_b64 exec, 0xffff
  buffer_load_dwordx4 v7, s[8:11], s81 offen lds
  s_mov_b64 exec, -1
  s_waitcnt vmcnt(6)
  s_barrier
  s_waitcnt lgkmcnt(0)
  v_mfma_f32_16x16x32_bf16 v[64:67], v[112:115], a[80:83], v[64:67]
  ds_read_b128 a[96:99], v16 offset:0
  ds_read_b128 a[100:103], v16 offset:2048
  v_mfma_f32_16x16x32_bf16 v[76:79], v[112:115], a[84:87], v[76:79]
  ds_read_b64_tr_b16 v[88:89], v18 offset:30720
  s_add_u32 m0, s54, 8192
  ds_read_b64_tr_b16 v[90:91], v18 offset:32000
  buffer_load_dwordx4 v2, s[4:7], s72 offen lds
  v_mfma_f32_16x16x32_bf16 v[68:71], v[116:119], a[80:83], v[68:71]
  ds_read_b64_tr_b16 v[92:93], v18 offset:30728
  ds_read_b64_tr_b16 v[94:95], v18 offset:32008
  v_mfma_f32_16x16x32_bf16 v[80:83], v[116:119], a[84:87], v[80:83]
  ds_read_b64_tr_b16 v[96:97], v19 offset:30720
  s_add_u32 m0, s54, 9216
  ds_read_b64_tr_b16 v[98:99], v19 offset:32000
  buffer_load_dwordx4 v3, s[4:7], s72 offen lds
  v_mfma_f32_16x16x32_bf16 v[72:75], v[120:123], a[80:83], v[72:75]
  ds_read_b128 a[104:107], v17 offset:0
  v_mfma_f32_16x16x32_bf16 v[84:87], v[120:123], a[84:87], v[84:87]
  s_add_u32 m0, s54, 10240
  ds_read_b128 a[108:111], v17 offset:2048
  buffer_load_dwordx4 v4, s[4:7], s72 offen lds
  v_mfma_f32_16x16x32_bf16 v[64:67], v[124:127], a[88:91], v[64:67]
  ds_read_b64_tr_b16 v[100:101], v18 offset:33280
  v_mfma_f32_16x16x32_bf16 v[76:79], v[124:127], a[92:95], v[76:79]
  s_add_u32 m0, s54, 11264
  ds_read_b64_tr_b16 v[102:103], v18 offset:34560
  buffer_load_dwordx4 v5, s[4:7], s72 offen lds
  v_mfma_f32_16x16x32_bf16 v[68:71], v[128:131], a[88:91], v[68:71]
  ds_read_b64_tr_b16 v[104:105], v18 offset:33288
  v_mfma_f32_16x16x32_bf16 v[80:83], v[128:131], a[92:95], v[80:83]
  s_add_u32 m0, s47, 40960
  ds_read_b64_tr_b16 v[106:107], v18 offset:34568
  buffer_load_dwordx4 v6, s[8:11], s82 offen lds
  v_mfma_f32_16x16x32_bf16 v[72:75], v[132:135], a[88:91], v[72:75]
  ds_read_b64_tr_b16 v[108:109], v19 offset:33280
  v_mfma_f32_16x16x32_bf16 v[84:87], v[132:135], a[92:95], v[84:87]
  ds_read_b64_tr_b16 v[110:111], v19 offset:34560
  s_add_u32 m0, s47, 41984
  s_mov_b64 exec, 0xffff
  buffer_load_dwordx4 v7, s[8:11], s82 offen lds
  s_mov_b64 exec, -1
  s_waitcnt vmcnt(6)
  s_barrier
  s_waitcnt lgkmcnt(0)
  v_mfma_f32_16x16x32_bf16 v[64:67], v[88:91], a[96:99], v[64:67]
  ds_read_b128 a[112:115], v16 offset:4096
  ds_read_b128 a[116:119], v16 offset:6144
  v_mfma_f32_16x16x32_bf16 v[76:79], v[88:91], a[100:103], v[76:79]
  ds_read_b64_tr_b16 v[112:113], v18 offset:35840
  s_add_u32 m0, s54, 0
  ds_read_b64_tr_b16 v[114:115], v18 offset:37120
  buffer_load_dwordx4 v2, s[4:7], s73 offen lds
  v_mfma_f32_16x16x32_bf16 v[68:71], v[92:95], a[96:99], v[68:71]
  ds_read_b64_tr_b16 v[116:117], v18 offset:35848
  ds_read_b64_tr_b16 v[118:119], v18 offset:37128
  v_mfma_f32_16x16x32_bf16 v[80:83], v[92:95], a[100:103], v[80:83]
  ds_read_b64_tr_b16 v[120:121], v19 offset:35840
  s_add_u32 m0, s54, 1024
  ds_read_b64_tr_b16 v[122:123], v19 offset:37120
  buffer_load_dwordx4 v3, s[4:7], s73 offen lds
  v_mfma_f32_16x16x32_bf16 v[72:75], v[96:99], a[96:99], v[72:75]
  ds_read_b128 a[120:123], v17 offset:4096
  v_mfma_f32_16x16x32_bf16 v[84:87], v[96:99], a[100:103], v[84:87]
  s_add_u32 m0, s54, 2048
  ds_read_b128 a[124:127], v17 offset:6144
  buffer_load_dwordx4 v4, s[4:7], s73 offen lds
  v_mfma_f32_16x16x32_bf16 v[64:67], v[100:103], a[104:107], v[64:67]
  ds_read_b64_tr_b16 v[124:125], v18 offset:38400
  v_mfma_f32_16x16x32_bf16 v[76:79], v[100:103], a[108:111], v[76:79]
  s_add_u32 m0, s54, 3072
  ds_read_b64_tr_b16 v[126:127], v18 offset:39680
  buffer_load_dwordx4 v5, s[4:7], s73 offen lds
  v_mfma_f32_16x16x32_bf16 v[68:71], v[104:107], a[104:107], v[68:71]
  ds_read_b64_tr_b16 v[128:129], v18 offset:38408
  v_mfma_f32_16x16x32_bf16 v[80:83], v[104:107], a[108:111], v[80:83]
  s_add_u32 m0, s47, 46080
  ds_read_b64_tr_b16 v[130:131], v18 offset:39688
  buffer_load_dwordx4 v6, s[8:11], s83 offen lds
  v_mfma_f32_16x16x32_bf16 v[72:75], v[108:111], a[104:107], v[72:75]
  ds_read_b64_tr_b16 v[132:133], v19 offset:38400
  v_mfma_f32_16x16x32_bf16 v[84:87], v[108:111], a[108:111], v[84:87]
  ds_read_b64_tr_b16 v[134:135], v19 offset:39680
  s_add_u32 m0, s47, 47104
  s_mov_b64 exec, 0xffff
  buffer_load_dwordx4 v7, s[8:11], s83 offen lds
  s_mov_b64 exec, -1
  s_waitcnt vmcnt(6)
  s_barrier
  s_waitcnt lgkmcnt(0)
  v_mfma_f32_16x16x32_bf16 v[64:67], v[112:115], a[112:115], v[64:67]
  ds_read_b128 a[128:131], v16 offset:8192
  ds_read_b128 a[132:135], v16 offset:10240
  v_mfma_f32_16x16x32_bf16 v[76:79], v[112:115], a[116:119], v[76:79]
  ds_read_b64_tr_b16 v[88:89], v18 offset:40960
  s_add_u32 m0, s60, 51200
  ds_read_b64_tr_b16 v[90:91], v18 offset:42240
  buffer_load_dwordx4 v248, s[12:15], s33 offen lds
  v_mfma_f32_16x16x32_bf16 v[68:71], v[116:119], a[112:115], v[68:71]
  ds_read_b64_tr_b16 v[92:93], v18 offset:40968
  ds_read_b64_tr_b16 v[94:95], v18 offset:42248
  v_mfma_f32_16x16x32_bf16 v[80:83], v[116:119], a[116:119], v[80:83]
  ds_read_b64_tr_b16 v[96:97], v19 offset:40960
  s_add_u32 m0, s60, 52224
  ds_read_b64_tr_b16 v[98:99], v19 offset:42240
  buffer_load_dwordx4 v249, s[12:15], s33 offen lds
  v_mfma_f32_16x16x32_bf16 v[72:75], v[120:123], a[112:115], v[72:75]
  ds_read_b128 a[136:139], v17 offset:8192
  v_mfma_f32_16x16x32_bf16 v[84:87], v[120:123], a[116:119], v[84:87]
  ds_read_b128 a[140:143], v17 offset:10240
  v_mfma_f32_16x16x32_bf16 v[64:67], v[124:127], a[120:123], v[64:67]
  ds_read_b64_tr_b16 v[100:101], v18 offset:43520
  v_mfma_f32_16x16x32_bf16 v[76:79], v[124:127], a[124:127], v[76:79]
  ds_read_b64_tr_b16 v[102:103], v18 offset:44800
  v_mfma_f32_16x16x32_bf16 v[68:71], v[128:131], a[120:123], v[68:71]
  ds_read_b64_tr_b16 v[104:105], v18 offset:43528
  v_mfma_f32_16x16x32_bf16 v[80:83], v[128:131], a[124:127], v[80:83]
  ds_read_b64_tr_b16 v[106:107], v18 offset:44808
  v_mfma_f32_16x16x32_bf16 v[72:75], v[132:135], a[120:123], v[72:75]
  ds_read_b64_tr_b16 v[108:109], v19 offset:43520
  v_mfma_f32_16x16x32_bf16 v[84:87], v[132:135], a[124:127], v[84:87]
  ds_read_b64_tr_b16 v[110:111], v19 offset:44800
  s_waitcnt vmcnt(2)
  s_barrier
  s_waitcnt lgkmcnt(0)
  v_mfma_f32_16x16x32_bf16 v[64:67], v[88:91], a[128:131], v[64:67]
  ds_read_b128 a[144:147], v16 offset:0
  ds_read_b128 a[148:151], v16 offset:2048
  v_mfma_f32_16x16x32_bf16 v[76:79], v[88:91], a[132:135], v[76:79]
  ds_read_b64_tr_b16 v[112:113], v18 offset:46080
  s_add_u32 m0, s60, 53248
  ds_read_b64_tr_b16 v[114:115], v18 offset:47360
  buffer_load_dwordx4 v250, s[12:15], s33 offen lds
  v_mfma_f32_16x16x32_bf16 v[68:71], v[92:95], a[128:131], v[68:71]
  ds_read_b64_tr_b16 v[116:117], v18 offset:46088
  ds_read_b64_tr_b16 v[118:119], v18 offset:47368
  v_mfma_f32_16x16x32_bf16 v[80:83], v[92:95], a[132:135], v[80:83]
  ds_read_b64_tr_b16 v[120:121], v19 offset:46080
  s_add_u32 m0, s60, 54272
  ds_read_b64_tr_b16 v[122:123], v19 offset:47360
  buffer_load_dwordx4 v251, s[12:15], s33 offen lds
  v_mfma_f32_16x16x32_bf16 v[72:75], v[96:99], a[128:131], v[72:75]
  ds_read_b128 a[152:155], v17 offset:0
  v_mfma_f32_16x16x32_bf16 v[84:87], v[96:99], a[132:135], v[84:87]
  ds_read_b128 a[156:159], v17 offset:2048
  v_mfma_f32_16x16x32_bf16 v[64:67], v[100:103], a[136:139], v[64:67]
  ds_read_b64_tr_b16 v[124:125], v18 offset:48640
  v_mfma_f32_16x16x32_bf16 v[76:79], v[100:103], a[140:143], v[76:79]
  ds_read_b64_tr_b16 v[126:127], v18 offset:49920
  v_mfma_f32_16x16x32_bf16 v[68:71], v[104:107], a[136:139], v[68:71]
  ds_read_b64_tr_b16 v[128:129], v18 offset:48648
  v_mfma_f32_16x16x32_bf16 v[80:83], v[104:107], a[140:143], v[80:83]
  ds_read_b64_tr_b16 v[130:131], v18 offset:49928
  v_mfma_f32_16x16x32_bf16 v[72:75], v[108:111], a[136:139], v[72:75]
  ds_read_b64_tr_b16 v[132:133], v19 offset:48640
  v_mfma_f32_16x16x32_bf16 v[84:87], v[108:111], a[140:143], v[84:87]
  ds_read_b64_tr_b16 v[134:135], v19 offset:49920
  s_waitcnt lgkmcnt(0)
  v_mfma_f32_16x16x32_bf16 v[64:67], v[112:115], a[144:147], v[64:67]
  s_add_u32 m0, s60, 55296
  v_mfma_f32_16x16x32_bf16 v[76:79], v[112:115], a[148:151], v[76:79]
  buffer_load_dwordx4 v252, s[12:15], s33 offen lds
  v_mfma_f32_16x16x32_bf16 v[68:71], v[116:119], a[144:147], v[68:71]
  v_mfma_f32_16x16x32_bf16 v[80:83], v[116:119], a[148:151], v[80:83]
  v_mfma_f32_16x16x32_bf16 v[72:75], v[120:123], a[144:147], v[72:75]
  v_mfma_f32_16x16x32_bf16 v[84:87], v[120:123], a[148:151], v[84:87]
  v_mfma_f32_16x16x32_bf16 v[64:67], v[124:127], a[152:155], v[64:67]
  v_mfma_f32_16x16x32_bf16 v[76:79], v[124:127], a[156:159], v[76:79]
  v_mfma_f32_16x16x32_bf16 v[68:71], v[128:131], a[152:155], v[68:71]
  v_mfma_f32_16x16x32_bf16 v[80:83], v[128:131], a[156:159], v[80:83]
  v_mfma_f32_16x16x32_bf16 v[72:75], v[132:135], a[152:155], v[72:75]
  v_mfma_f32_16x16x32_bf16 v[84:87], v[132:135], a[156:159], v[84:87]
  s_barrier
  s_cmp_lg_u32 s40, 0
  s_cbranch_scc1 L_noflag
  s_lshl_b32 s48, s2, 2
  s_add_u32 s48, s48, 983040
  v_mov_b32 v62, s48
  v_mov_b32 v63, s57
  s_mov_b64 exec, 1
  buffer_store_dword v63, v62, s[36:39], 0 offen sc1
  s_mov_b64 exec, -1
L_noflag:
  v_cvt_pk_bf16_f32 v136, v64, v65
  v_cvt_pk_bf16_f32 v137, v66, v67
  v_cvt_pk_bf16_f32 v138, v68, v69
  v_cvt_pk_bf16_f32 v139, v70, v71
  v_cvt_pk_bf16_f32 v140, v76, v77
  v_cvt_pk_bf16_f32 v141, v78, v79
  v_cvt_pk_bf16_f32 v142, v80, v81
  v_cvt_pk_bf16_f32 v143, v82, v83
  v_cvt_pk_bf16_f32 v144, v72, v73
  v_cvt_pk_bf16_f32 v145, v74, v75
  v_cvt_pk_bf16_f32 v146, v84, v85
  v_cvt_pk_bf16_f32 v147, v86, v87
  v_mfma_f32_16x16x32_bf16 v[148:151], a[160:163], v[136:139], 0
  v_mfma_f32_16x16x32_bf16 v[152:155], a[172:175], v[136:139], 0
  v_mfma_f32_16x16x32_bf16 v[156:159], a[184:187], v[136:139], 0
  v_mfma_f32_16x16x32_bf16 v[160:163], a[196:199], v[136:139], 0
  v_mfma_f32_16x16x32_bf16 v[164:167], a[208:211], v[136:139], 0
  v_mfma_f32_16x16x32_bf16 v[148:151], a[164:167], v[140:143], v[148:151]
  v_mfma_f32_16x16x32_bf16 v[152:155], a[176:179], v[140:143], v[152:155]
  v_mfma_f32_16x16x32_bf16 v[156:159], a[188:191], v[140:143], v[156:159]
  v_mfma_f32_16x16x32_bf16 v[160:163], a[200:203], v[140:143], v[160:163]
  v_mfma_f32_16x16x32_bf16 v[164:167], a[212:215], v[140:143], v[164:167]
  s_add_u32 m0, s60, 71680
  v_mfma_f32_16x16x32_bf16 v[148:151], a[168:171], v[144:147], v[148:151]
  buffer_load_dwordx4 v248, s[12:15], s34 offen lds
  v_mfma_f32_16x16x32_bf16 v[152:155], a[180:183], v[144:147], v[152:155]
  v_mfma_f32_16x16x32_bf16 v[156:159], a[192:195], v[144:147], v[156:159]
  v_mfma_f32_16x16x32_bf16 v[160:163], a[204:207], v[144:147], v[160:163]
  v_mfma_f32_16x16x32_bf16 v[164:167], a[216:219], v[144:147], v[164:167]
  s_nop 2
  v_max3_f32 v56, v148, v149, v150
  v_min3_f32 v58, v148, v149, v150
  v_max3_f32 v56, v56, v151, v152
  v_min3_f32 v58, v58, v151, v152
  v_max3_f32 v56, v56, v153, v154
  v_min3_f32 v58, v58, v153, v154
  v_max3_f32 v56, v56, v155, v156
  v_min3_f32 v58, v58, v155, v156
  v_max3_f32 v56, v56, v157, v158
  v_min3_f32 v58, v58, v157, v158
  v_max3_f32 v56, v56, v159, v160
  v_min3_f32 v58, v58, v159, v160
  v_max3_f32 v56, v56, v161, v162
  v_min3_f32 v58, v58, v161, v162
  v_max3_f32 v56, v56, v163, v164
  v_min3_f32 v58, v58, v163, v164
  v_max3_f32 v56, v56, v165, v166
  v_min3_f32 v58, v58, v165, v166
  v_max_f32 v56, v56, v167
  v_min_f32 v58, v58, v167
  v_mul_f32 v56, s55, v56
  s_add_u32 m0, s60, 72704
  v_mul_f32 v58, s55, v58
  buffer_load_dwordx4 v249, s[12:15], s34 offen lds
  s_mov_b32 s48, s55
  s_mov_b32 s49, s55
  v_pk_fma_f32 v[168:169], v[148:149], s[48:49], v[56:57] op_sel_hi:[1,1,0] neg_lo:[0,0,1] neg_hi:[0,0,1]
  v_pk_fma_f32 v[188:189], v[148:149], s[48:49], v[58:59] op_sel_hi:[1,1,0] neg_lo:[1,0,0] neg_hi:[1,0,0]
  v_pk_fma_f32 v[170:171], v[150:151], s[48:49], v[56:57] op_sel_hi:[1,1,0] neg_lo:[0,0,1] neg_hi:[0,0,1]
  v_pk_fma_f32 v[190:191], v[150:151], s[48:49], v[58:59] op_sel_hi:[1,1,0] neg_lo:[1,0,0] neg_hi:[1,0,0]
  v_pk_fma_f32 v[172:173], v[152:153], s[48:49], v[56:57] op_sel_hi:[1,1,0] neg_lo:[0,0,1] neg_hi:[0,0,1]
  v_pk_fma_f32 v[192:193], v[152:153], s[48:49], v[58:59] op_sel_hi:[1,1,0] neg_lo:[1,0,0] neg_hi:[1,0,0]
  v_pk_fma_f32 v[174:175], v[154:155], s[48:49], v[56:57] op_sel_hi:[1,1,0] neg_lo:[0,0,1] neg_hi:[0,0,1]
  v_pk_fma_f32 v[194:195], v[154:155], s[48:49], v[58:59] op_sel_hi:[1,1,0] neg_lo:[1,0,0] neg_hi:[1,0,0]
  v_pk_fma_f32 v[176:177], v[156:157], s[48:49], v[56:57] op_sel_hi:[1,1,0] neg_lo:[0,0,1] neg_hi:[0,0,1]
  v_pk_fma_f32 v[196:197], v[156:157], s[48:49], v[58:59] op_sel_hi:[1,1,0] neg_lo:[1,0,0] neg_hi:[1,0,0]
  v_pk_fma_f32 v[178:179], v[158:159], s[48:49], v[56:57] op_sel_hi:[1,1,0] neg_lo:[0,0,1] neg_hi:[0,0,1]
  v_pk_fma_f32 v[198:199], v[158:159], s[48:49], v[58:59] op_sel_hi:[1,1,0] neg_lo:[1,0,0] neg_hi:[1,0,0]
  v_pk_fma_f32 v[180:181], v[160:161], s[48:49], v[56:57] op_sel_hi:[1,1,0] neg_lo:[0,0,1] neg_hi:[0,0,1]
  v_pk_fma_f32 v[200:201], v[160:161], s[48:49], v[58:59] op_sel_hi:[1,1,0] neg_lo:[1,0,0] neg_hi:[1,0,0]
  v_pk_fma_f32 v[182:183], v[162:163], s[48:49], v[56:57] op_sel_hi:[1,1,0] neg_lo:[0,0,1] neg_hi:[0,0,1]
  v_pk_fma_f32 v[202:203], v[162:163], s[48:49], v[58:59] op_sel_hi:[1,1,0] neg_lo:[1,0,0] neg_hi:[1,0,0]
  v_pk_fma_f32 v[184:185], v[164:165], s[48:49], v[56:57] op_sel_hi:[1,1,0] neg_lo:[0,0,1] neg_hi:[0,0,1]
  v_pk_fma_f32 v[204:205], v[164:165], s[48:49], v[58:59] op_sel_hi:[1,1,0] neg_lo:[1,0,0] neg_hi:[1,0,0]
  v_pk_fma_f32 v[186:187], v[166:167], s[48:49], v[56:57] op_sel_hi:[1,1,0] neg_lo:[0,0,1] neg_hi:[0,0,1]
  v_pk_fma_f32 v[206:207], v[166:167], s[48:49], v[58:59] op_sel_hi:[1,1,0] neg_lo:[1,0,0] neg_hi:[1,0,0]
  v_exp_f32 v168, v168
  v_exp_f32 v169, v169
  v_exp_f32 v170, v170
  v_exp_f32 v171, v171
  s_add_u32 m0, s60, 73728
  v_exp_f32 v172, v172
  buffer_load_dwordx4 v250, s[12:15], s34 offen lds
  v_exp_f32 v173, v173
  v_exp_f32 v174, v174
  v_exp_f32 v175, v175
  v_exp_f32 v176, v176
  v_exp_f32 v177, v177
  v_exp_f32 v178, v178
  v_exp_f32 v179, v179
  v_exp_f32 v180, v180
  v_exp_f32 v181, v181
  v_exp_f32 v182, v182
  v_exp_f32 v183, v183
  v_exp_f32 v184, v184
  v_exp_f32 v185, v185
  v_exp_f32 v186, v186
  v_exp_f32 v187, v187
  v_exp_f32 v188, v188
  v_exp_f32 v189, v189
  v_exp_f32 v190, v190
  v_exp_f32 v191, v191
  v_exp_f32 v192, v192
  v_exp_f32 v193, v193
  v_exp_f32 v194, v194
  v_exp_f32 v195, v195
  v_exp_f32 v196, v196
  v_exp_f32 v197, v197
  v_exp_f32 v198, v198
  s_add_u32 m0, s60, 74752
  v_exp_f32 v199, v199
  buffer_load_dwordx4 v251, s[12:15], s34 offen lds
  v_exp_f32 v200, v200
  v_exp_f32 v201, v201
  v_exp_f32 v202, v202
  v_exp_f32 v203, v203
  v_exp_f32 v204, v204
  v_exp_f32 v205, v205
  v_exp_f32 v206, v206
  v_exp_f32 v207, v207
  v_pk_add_f32 v[60:61], v[168:169], v[170:171]
  v_pk_add_f32 v[62:63], v[188:189], v[190:191]
  v_pk_add_f32 v[60:61], v[60:61], v[172:173]
  v_pk_add_f32 v[62:63], v[62:63], v[192:193]
  v_pk_add_f32 v[60:61], v[60:61], v[174:175]
  v_pk_add_f32 v[62:63], v[62:63], v[194:195]
  v_pk_add_f32 v[60:61], v[60:61], v[176:177]
  v_pk_add_f32 v[62:63], v[62:63], v[196:197]
  v_pk_add_f32 v[60:61], v[60:61], v[178:179]
  v_pk_add_f32 v[62:63], v[62:63], v[198:199]
  v_pk_add_f32 v[60:61], v[60:61], v[180:181]
  v_pk_add_f32 v[62:63], v[62:63], v[200:201]
  v_pk_add_f32 v[60:61], v[60:61], v[182:183]
  v_pk_add_f32 v[62:63], v[62:63], v[202:203]
  v_pk_add_f32 v[60:61], v[60:61], v[184:185]
  v_pk_add_f32 v[62:63], v[62:63], v[204:205]
  v_pk_add_f32 v[60:61], v[60:61], v[186:187]
  v_pk_add_f32 v[62:63], v[62:63], v[206:207]
  s_add_u32 m0, s60, 75776
  v_add_f32 v60, v60, v61
  buffer_load_dwordx4 v252, s[12:15], s34 offen lds
  v_add_f32 v62, v62, v63
  v_rcp_f32 v60, v60
  v_rcp_f32 v62, v62
  v_pk_mul_f32 v[168:169], v[168:169], v[60:61] op_sel_hi:[1,0]
  v_pk_mul_f32 v[188:189], v[188:189], v[62:63] op_sel_hi:[1,0]
  v_pk_mul_f32 v[170:171], v[170:171], v[60:61] op_sel_hi:[1,0]
  v_pk_mul_f32 v[190:191], v[190:191], v[62:63] op_sel_hi:[1,0]
  v_pk_mul_f32 v[172:173], v[172:173], v[60:61] op_sel_hi:[1,0]
  v_pk_mul_f32 v[192:193], v[192:193], v[62:63] op_sel_hi:[1,0]
  v_pk_mul_f32 v[174:175], v[174:175], v[60:61] op_sel_hi:[1,0]
  v_pk_mul_f32 v[194:195], v[194:195], v[62:63] op_sel_hi:[1,0]
  v_pk_mul_f32 v[176:177], v[176:177], v[60:61] op_sel_hi:[1,0]
  v_pk_mul_f32 v[196:197], v[196:197], v[62:63] op_sel_hi:[1,0]
  v_pk_mul_f32 v[178:179], v[178:179], v[60:61] op_sel_hi:[1,0]
  v_pk_mul_f32 v[198:199], v[198:199], v[62:63] op_sel_hi:[1,0]
  v_pk_mul_f32 v[180:181], v[180:181], v[60:61] op_sel_hi:[1,0]
  v_pk_mul_f32 v[200:201], v[200:201], v[62:63] op_sel_hi:[1,0]
  v_pk_mul_f32 v[182:183], v[182:183], v[60:61] op_sel_hi:[1,0]
  v_pk_mul_f32 v[202:203], v[202:203], v[62:63] op_sel_hi:[1,0]
  v_pk_mul_f32 v[184:185], v[184:185], v[60:61] op_sel_hi:[1,0]
  v_pk_mul_f32 v[204:205], v[204:205], v[62:63] op_sel_hi:[1,0]
  v_pk_mul_f32 v[186:187], v[186:187], v[60:61] op_sel_hi:[1,0]
  v_pk_mul_f32 v[206:207], v[206:207], v[62:63] op_sel_hi:[1,0]
  v_cvt_pk_bf16_f32 v208, v168, v169
  v_cvt_pk_bf16_f32 v209, v170, v171
  v_cvt_pk_bf16_f32 v210, v172, v173
  buffer_load_dword v243, v242, s[36:39], 0 offen
  v_cvt_pk_bf16_f32 v211, v174, v175
  ds_write_b128 v24, v[208:211] offset:0
  v_cvt_pk_bf16_f32 v212, v176, v177
  v_cvt_pk_bf16_f32 v213, v178, v179
  v_cvt_pk_bf16_f32 v214, v180, v181
  v_cvt_pk_bf16_f32 v215, v182, v183
  ds_write_b128 v24, v[212:215] offset:16
  v_cvt_pk_bf16_f32 v216, v184, v185
  v_cvt_pk_bf16_f32 v217, v186, v187
  v_cvt_pk_bf16_f32 v218, v188, v189
  v_cvt_pk_bf16_f32 v219, v190, v191
  ds_write_b128 v24, v[216:219] offset:32
  v_cvt_pk_bf16_f32 v220, v192, v193
  v_cvt_pk_bf16_f32 v221, v194, v195
  v_cvt_pk_bf16_f32 v222, v196, v197
  v_cvt_pk_bf16_f32 v223, v198, v199
  ds_write_b128 v24, v[220:223] offset:48
  v_cvt_pk_bf16_f32 v224, v200, v201
  v_cvt_pk_bf16_f32 v225, v202, v203
  v_cvt_pk_bf16_f32 v226, v204, v205
  v_cvt_pk_bf16_f32 v227, v206, v207
  ds_write_b128 v24, v[224:227] offset:64
  s_waitcnt vmcnt(6)
  s_barrier
  ds_read_b64_tr_b16 v[88:89], v20 offset:0
  ds_read_b64_tr_b16 v[90:91], v20 offset:1280
  ds_read_b64_tr_b16 v[92:93], v20 offset:40
  ds_read_b64_tr_b16 v[94:95], v20 offset:1320
  ds_read_b64_tr_b16 v[96:97], v21 offset:0
  ds_read_b64_tr_b16 v[98:99], v21 offset:1280
  ds_read_b64_tr_b16 v[100:101], v20 offset:2560
  ds_read_b64_tr_b16 v[102:103], v20 offset:3840
  ds_read_b64_tr_b16 v[104:105], v20 offset:2600
  ds_read_b64_tr_b16 v[106:107], v20 offset:3880
  ds_read_b64_tr_b16 v[108:109], v21 offset:2560
  ds_read_b64_tr_b16 v[110:111], v21 offset:3840
  s_waitcnt lgkmcnt(6)
  v_mfma_f32_16x16x32_bf16 v[64:67], a[0:3], v[88:91], 0
  ds_read_b64_tr_b16 v[112:113], v20 offset:5120
  v_mfma_f32_16x16x32_bf16 v[76:79], a[4:7], v[88:91], 0
  ds_read_b64_tr_b16 v[114:115], v20 offset:6400
  s_cmp_ge_u32 s40, 2
  s_cbranch_scc1 L_skg_V2_0
  s_add_u32 m0, s60, 92160
  s_nop 0
  buffer_load_dwordx4 v248, s[12:15], s35 offen lds
L_skg_V2_0:
  v_mfma_f32_16x16x32_bf16 v[68:71], a[0:3], v[92:95], 0
  ds_read_b64_tr_b16 v[116:117], v20 offset:5160
  v_mfma_f32_16x16x32_bf16 v[80:83], a[4:7], v[92:95], 0
  ds_read_b64_tr_b16 v[118:119], v20 offset:6440
  v_mfma_f32_16x16x32_bf16 v[72:75], a[0:3], v[96:99], 0
  ds_read_b64_tr_b16 v[120:121], v21 offset:5120
  v_mfma_f32_16x16x32_bf16 v[84:87], a[4:7], v[96:99], 0
  ds_read_b64_tr_b16 v[122:123], v21 offset:6400
  s_waitcnt lgkmcnt(6)
  v_mfma_f32_16x16x32_bf16 v[64:67], a[8:11], v[100:103], v[64:67]
  ds_read_b64_tr_b16 v[124:125], v20 offset:7680
  v_mfma_f32_16x16x32_bf16 v[76:79], a[12:15], v[100:103], v[76:79]
  ds_read_b64_tr_b16 v[126:127], v20 offset:8960
  s_cmp_ge_u32 s40, 2
  s_cbranch_scc1 L_skg_V2_1
  s_add_u32 m0, s60, 93184
  s_nop 0
  buffer_load_dwordx4 v249, s[12:15], s35 offen lds
L_skg_V2_1:
  v_mfma_f32_16x16x32_bf16 v[68:71], a[8:11], v[104:107], v[68:71]
  ds_read_b64_tr_b16 v[128:129], v20 offset:7720
  v_mfma_f32_16x16x32_bf16 v[80:83], a[12:15], v[104:107], v[80:83]
  ds_read_b64_tr_b16 v[130:131], v20 offset:9000
  v_mfma_f32_16x16x32_bf16 v[72:75], a[8:11], v[108:111], v[72:75]
  ds_read_b64_tr_b16 v[132:133], v21 offset:7680
  v_mfma_f32_16x16x32_bf16 v[84:87], a[12:15], v[108:111], v[84:87]
  ds_read_b64_tr_b16 v[134:135], v21 offset:8960
  s_waitcnt lgkmcnt(6)
  v_mfma_f32_16x16x32_bf16 v[64:67], a[16:19], v[112:115], v[64:67]
  ds_read_b64_tr_b16 v[88:89], v20 offset:10240
  v_mfma_f32_16x16x32_bf16 v[76:79], a[20:23], v[112:115], v[76:79]
  ds_read_b64_tr_b16 v[90:91], v20 offset:11520
  s_cmp_ge_u32 s40, 2
  s_cbranch_scc1 L_skg_V2_2
  s_add_u32 m0, s60, 94208
  s_nop 0
  buffer_load_dwordx4 v250, s[12:15], s35 offen lds
L_skg_V2_2:
  v_mfma_f32_16x16x32_bf16 v[68:71], a[16:19], v[116:119], v[68:71]
  ds_read_b64_tr_b16 v[92:93], v20 offset:10280
  v_mfma_f32_16x16x32_bf16 v[80:83], a[20:23], v[116:119], v[80:83]
  ds_read_b64_tr_b16 v[94:95], v20 offset:11560
  v_mfma_f32_16x16x32_bf16 v[72:75], a[16:19], v[120:123], v[72:75]
  ds_read_b64_tr_b16 v[96:97], v21 offset:10240
  v_mfma_f32_16x16x32_bf16 v[84:87], a[20:23], v[120:123], v[84:87]
  ds_read_b64_tr_b16 v[98:99], v21 offset:11520
  s_waitcnt lgkmcnt(6)
  v_mfma_f32_16x16x32_bf16 v[64:67], a[24:27], v[124:127], v[64:67]
  ds_read_b64_tr_b16 v[100:101], v20 offset:12800
  v_mfma_f32_16x16x32_bf16 v[76:79], a[28:31], v[124:127], v[76:79]
  ds_read_b64_tr_b16 v[102:103], v20 offset:14080
  s_cmp_ge_u32 s40, 2
  s_cbranch_scc1 L_skg_V2_3
  s_add_u32 m0, s60, 95232
  s_nop 0
  buffer_load_dwordx4 v251, s[12:15], s35 offen lds
L_skg_V2_3:
  v_mfma_f32_16x16x32_bf16 v[68:71], a[24:27], v[128:131], v[68:71]
  ds_read_b64_tr_b16 v[104:105], v20 offset:12840
  v_mfma_f32_16x16x32_bf16 v[80:83], a[28:31], v[128:131], v[80:83]
  ds_read_b64_tr_b16 v[106:107], v20 offset:14120
  v_mfma_f32_16x16x32_bf16 v[72:75], a[24:27], v[132:135], v[72:75]
  ds_read_b64_tr_b16 v[108:109], v21 offset:12800
  v_mfma_f32_16x16x32_bf16 v[84:87], a[28:31], v[132:135], v[84:87]
  ds_read_b64_tr_b16 v[110:111], v21 offset:14080
  s_waitcnt lgkmcnt(6)
  v_mfma_f32_16x16x32_bf16 v[64:67], a[32:35], v[88:91], v[64:67]
  ds_read_b64_tr_b16 v[112:113], v20 offset:15360
  v_mfma_f32_16x16x32_bf16 v[76:79], a[36:39], v[88:91], v[76:79]
  ds_read_b64_tr_b16 v[114:115], v20 offset:16640
  s_cmp_ge_u32 s40, 2
  s_cbranch_scc1 L_skg_V2_4
  s_add_u32 m0, s60, 96256
  s_nop 0
  buffer_load_dwordx4 v252, s[12:15], s35 offen lds
L_skg_V2_4:
  v_mfma_f32_16x16x32_bf16 v[68:71], a[32:35], v[92:95], v[68:71]
  ds_read_b64_tr_b16 v[116:117], v20 offset:15400
  v_mfma_f32_16x16x32_bf16 v[80:83], a[36:39], v[92:95], v[80:83]
  ds_read_b64_tr_b16 v[118:119], v20 offset:16680
  v_mfma_f32_16x16x32_bf16 v[72:75], a[32:35], v[96:99], v[72:75]
  ds_read_b64_tr_b16 v[120:121], v21 offset:15360
  v_mfma_f32_16x16x32_bf16 v[84:87], a[36:39], v[96:99], v[84:87]
  ds_read_b64_tr_b16 v[122:123], v21 offset:16640
  s_waitcnt lgkmcnt(6)
  v_mfma_f32_16x16x32_bf16 v[64:67], a[40:43], v[100:103], v[64:67]
  ds_read_b64_tr_b16 v[124:125], v20 offset:17920
  v_mfma_f32_16x16x32_bf16 v[76:79], a[44:47], v[100:103], v[76:79]
  ds_read_b64_tr_b16 v[126:127], v20 offset:19200
  buffer_load_dword v53, v238, s[24:27], 0 offen
  v_mfma_f32_16x16x32_bf16 v[68:71], a[40:43], v[104:107], v[68:71]
  ds_read_b64_tr_b16 v[128:129], v20 offset:17960
  v_mfma_f32_16x16x32_bf16 v[80:83], a[44:47], v[104:107], v[80:83]
  ds_read_b64_tr_b16 v[130:131], v20 offset:19240
  v_mfma_f32_16x16x32_bf16 v[72:75], a[40:43], v[108:111], v[72:75]
  ds_read_b64_tr_b16 v[132:133], v21 offset:17920
  v_mfma_f32_16x16x32_bf16 v[84:87], a[44:47], v[108:111], v[84:87]
  ds_read_b64_tr_b16 v[134:135], v21 offset:19200
  s_waitcnt vmcnt(2)
  s_barrier
  s_waitcnt lgkmcnt(6)
  v_mfma_f32_16x16x32_bf16 v[64:67], a[48:51], v[112:115], v[64:67]
  ds_read_b64_tr_b16 v[88:89], v20 offset:20480
  v_mfma_f32_16x16x32_bf16 v[76:79], a[52:55], v[112:115], v[76:79]
  s_add_u32 m0, s60, 0
  ds_read_b64_tr_b16 v[90:91], v20 offset:21760
  buffer_load_dwordx4 v248, s[16:19], s33 offen lds
  v_mfma_f32_16x16x32_bf16 v[68:71], a[48:51], v[116:119], v[68:71]
  ds_read_b64_tr_b16 v[92:93], v20 offset:20520
  v_mfma_f32_16x16x32_bf16 v[80:83], a[52:55], v[116:119], v[80:83]
  ds_read_b64_tr_b16 v[94:95], v20 offset:21800
  v_mfma_f32_16x16x32_bf16 v[72:75], a[48:51], v[120:123], v[72:75]
  ds_read_b64_tr_b16 v[96:97], v21 offset:20480
  v_mfma_f32_16x16x32_bf16 v[84:87], a[52:55], v[120:123], v[84:87]
  ds_read_b64_tr_b16 v[98:99], v21 offset:21760
  s_waitcnt lgkmcnt(6)
  v_mfma_f32_16x16x32_bf16 v[64:67], a[56:59], v[124:127], v[64:67]
  ds_read_b64_tr_b16 v[100:101], v20 offset:23040
  v_mfma_f32_16x16x32_bf16 v[76:79], a[60:63], v[124:127], v[76:79]
  ds_read_b64_tr_b16 v[102:103], v20 offset:24320
  v_mfma_f32_16x16x32_bf16 v[68:71], a[56:59], v[128:131], v[68:71]
  ds_read_b64_tr_b16 v[104:105], v20 offset:23080
  v_mfma_f32_16x16x32_bf16 v[80:83], a[60:63], v[128:131], v[80:83]
  ds_read_b64_tr_b16 v[106:107], v20 offset:24360
  v_mfma_f32_16x16x32_bf16 v[72:75], a[56:59], v[132:135], v[72:75]
  ds_read_b64_tr_b16 v[108:109], v21 offset:23040
  v_mfma_f32_16x16x32_bf16 v[84:87], a[60:63], v[132:135], v[84:87]
  ds_read_b64_tr_b16 v[110:111], v21 offset:24320
  s_waitcnt lgkmcnt(6)
  v_mfma_f32_16x16x32_bf16 v[64:67], a[64:67], v[88:91], v[64:67]
  ds_read_b64_tr_b16 v[112:113], v20 offset:25600
  v_mfma_f32_16x16x32_bf16 v[76:79], a[68:71], v[88:91], v[76:79]
  s_add_u32 m0, s60, 1024
  ds_read_b64_tr_b16 v[114:115], v20 offset:26880
  buffer_load_dwordx4 v249, s[16:19], s33 offen lds
  v_mfma_f32_16x16x32_bf16 v[68:71], a[64:67], v[92:95], v[68:71]
  ds_read_b64_tr_b16 v[116:117], v20 offset:25640
  v_mfma_f32_16x16x32_bf16 v[80:83], a[68:71], v[92:95], v[80:83]
  ds_read_b64_tr_b16 v[118:119], v20 offset:26920
  v_mfma_f32_16x16x32_bf16 v[72:75], a[64:67], v[96:99], v[72:75]
  ds_read_b64_tr_b16 v[120:121], v21 offset:25600
  v_mfma_f32_16x16x32_bf16 v[84:87], a[68:71], v[96:99], v[84:87]
  ds_read_b64_tr_b16 v[122:123], v21 offset:26880
  s_waitcnt lgkmcnt(6)
  v_mfma_f32_16x16x32_bf16 v[64:67], a[72:75], v[100:103], v[64:67]
  ds_read_b64_tr_b16 v[124:125], v20 offset:28160
  v_mfma_f32_16x16x32_bf16 v[76:79], a[76:79], v[100:103], v[76:79]
  ds_read_b64_tr_b16 v[126:127], v20 offset:29440
  v_mfma_f32_16x16x32_bf16 v[68:71], a[72:75], v[104:107], v[68:71]
  ds_read_b64_tr_b16 v[128:129], v20 offset:28200
  v_mfma_f32_16x16x32_bf16 v[80:83], a[76:79], v[104:107], v[80:83]
  ds_read_b64_tr_b16 v[130:131], v20 offset:29480
  v_mfma_f32_16x16x32_bf16 v[72:75], a[72:75], v[108:111], v[72:75]
  ds_read_b64_tr_b16 v[132:133], v21 offset:28160
  v_mfma_f32_16x16x32_bf16 v[84:87], a[76:79], v[108:111], v[84:87]
  ds_read_b64_tr_b16 v[134:135], v21 offset:29440
  s_waitcnt lgkmcnt(6)
  v_mfma_f32_16x16x32_bf16 v[64:67], a[80:83], v[112:115], v[64:67]
  ds_read_b64_tr_b16 v[88:89], v20 offset:30720
  v_mfma_f32_16x16x32_bf16 v[76:79], a[84:87], v[112:115], v[76:79]
  s_add_u32 m0, s60, 2048
  ds_read_b64_tr_b16 v[90:91], v20 offset:32000
  buffer_load_dwordx4 v250, s[16:19], s33 offen lds
  v_mfma_f32_16x16x32_bf16 v[68:71], a[80:83], v[116:119], v[68:71]
  ds_read_b64_tr_b16 v[92:93], v20 offset:30760
  v_mfma_f32_16x16x32_bf16 v[80:83], a[84:87], v[116:119], v[80:83]
  ds_read_b64_tr_b16 v[94:95], v20 offset:32040
  v_mfma_f32_16x16x32_bf16 v[72:75], a[80:83], v[120:123], v[72:75]
  ds_read_b64_tr_b16 v[96:97], v21 offset:30720
  v_mfma_f32_16x16x32_bf16 v[84:87], a[84:87], v[120:123], v[84:87]
  ds_read_b64_tr_b16 v[98:99], v21 offset:32000
  s_waitcnt lgkmcnt(6)
  v_mfma_f32_16x16x32_bf16 v[64:67], a[88:91], v[124:127], v[64:67]
  ds_read_b64_tr_b16 v[100:101], v20 offset:33280
  v_mfma_f32_16x16x32_bf16 v[76:79], a[92:95], v[124:127], v[76:79]
  ds_read_b64_tr_b16 v[102:103], v20 offset:34560
  v_mfma_f32_16x16x32_bf16 v[68:71], a[88:91], v[128:131], v[68:71]
  ds_read_b64_tr_b16 v[104:105], v20 offset:33320
  v_mfma_f32_16x16x32_bf16 v[80:83], a[92:95], v[128:131], v[80:83]
  ds_read_b64_tr_b16 v[106:107], v20 offset:34600
  v_mfma_f32_16x16x32_bf16 v[72:75], a[88:91], v[132:135], v[72:75]
  ds_read_b64_tr_b16 v[108:109], v21 offset:33280
  v_mfma_f32_16x16x32_bf16 v[84:87], a[92:95], v[132:135], v[84:87]
  ds_read_b64_tr_b16 v[110:111], v21 offset:34560
  s_waitcnt lgkmcnt(6)
  v_mfma_f32_16x16x32_bf16 v[64:67], a[96:99], v[88:91], v[64:67]
  ds_read_b64_tr_b16 v[112:113], v20 offset:35840
  v_mfma_f32_16x16x32_bf16 v[76:79], a[100:103], v[88:91], v[76:79]
  s_add_u32 m0, s60, 3072
  ds_read_b64_tr_b16 v[114:115], v20 offset:37120
  buffer_load_dwordx4 v251, s[16:19], s33 offen lds
  v_mfma_f32_16x16x32_bf16 v[68:71], a[96:99], v[92:95], v[68:71]
  ds_read_b64_tr_b16 v[116:117], v20 offset:35880
  v_mfma_f32_16x16x32_bf16 v[80:83], a[100:103], v[92:95], v[80:83]
  ds_read_b64_tr_b16 v[118:119], v20 offset:37160
  v_mfma_f32_16x16x32_bf16 v[72:75], a[96:99], v[96:99], v[72:75]
  ds_read_b64_tr_b16 v[120:121], v21 offset:35840
  v_mfma_f32_16x16x32_bf16 v[84:87], a[100:103], v[96:99], v[84:87]
  ds_read_b64_tr_b16 v[122:123], v21 offset:37120
  s_waitcnt lgkmcnt(6)
  v_mfma_f32_16x16x32_bf16 v[64:67], a[104:107], v[100:103], v[64:67]
  ds_read_b64_tr_b16 v[124:125], v20 offset:38400
  v_mfma_f32_16x16x32_bf16 v[76:79], a[108:111], v[100:103], v[76:79]
  ds_read_b64_tr_b16 v[126:127], v20 offset:39680
  v_mfma_f32_16x16x32_bf16 v[68:71], a[104:107], v[104:107], v[68:71]
  ds_read_b64_tr_b16 v[128:129], v20 offset:38440
  v_mfma_f32_16x16x32_bf16 v[80:83], a[108:111], v[104:107], v[80:83]
  ds_read_b64_tr_b16 v[130:131], v20 offset:39720
  v_mfma_f32_16x16x32_bf16 v[72:75], a[104:107], v[108:111], v[72:75]
  ds_read_b64_tr_b16 v[132:133], v21 offset:38400
  v_mfma_f32_16x16x32_bf16 v[84:87], a[108:111], v[108:111], v[84:87]
  ds_read_b64_tr_b16 v[134:135], v21 offset:39680
  s_waitcnt vmcnt(5)
  s_barrier
  s_waitcnt lgkmcnt(6)
  v_mfma_f32_16x16x32_bf16 v[64:67], a[112:115], v[112:115], v[64:67]
  ds_read_b64_tr_b16 v[88:89], v20 offset:40960
  v_mfma_f32_16x16x32_bf16 v[76:79], a[116:119], v[112:115], v[76:79]
  s_add_u32 m0, s60, 4096
  ds_read_b64_tr_b16 v[90:91], v20 offset:42240
  buffer_load_dwordx4 v252, s[16:19], s33 offen lds
  v_mfma_f32_16x16x32_bf16 v[68:71], a[112:115], v[116:119], v[68:71]
  ds_read_b64_tr_b16 v[92:93], v20 offset:41000
  v_mfma_f32_16x16x32_bf16 v[80:83], a[116:119], v[116:119], v[80:83]
  ds_read_b64_tr_b16 v[94:95], v20 offset:42280
  v_mfma_f32_16x16x32_bf16 v[72:75], a[112:115], v[120:123], v[72:75]
  ds_read_b64_tr_b16 v[96:97], v21 offset:40960
  v_mfma_f32_16x16x32_bf16 v[84:87], a[116:119], v[120:123], v[84:87]
  ds_read_b64_tr_b16 v[98:99], v21 offset:42240
  s_waitcnt lgkmcnt(6)
  v_mfma_f32_16x16x32_bf16 v[64:67], a[120:123], v[124:127], v[64:67]
  ds_read_b64_tr_b16 v[100:101], v20 offset:43520
  v_mfma_f32_16x16x32_bf16 v[76:79], a[124:127], v[124:127], v[76:79]
  ds_read_b64_tr_b16 v[102:103], v20 offset:44800
  v_mfma_f32_16x16x32_bf16 v[68:71], a[120:123], v[128:131], v[68:71]
  ds_read_b64_tr_b16 v[104:105], v20 offset:43560
  v_mfma_f32_16x16x32_bf16 v[80:83], a[124:127], v[128:131], v[80:83]
  ds_read_b64_tr_b16 v[106:107], v20 offset:44840
  v_mfma_f32_16x16x32_bf16 v[72:75], a[120:123], v[132:135], v[72:75]
  ds_read_b64_tr_b16 v[108:109], v21 offset:43520
  v_mfma_f32_16x16x32_bf16 v[84:87], a[124:127], v[132:135], v[84:87]
  ds_read_b64_tr_b16 v[110:111], v21 offset:44800
  s_waitcnt lgkmcnt(6)
  v_mfma_f32_16x16x32_bf16 v[64:67], a[128:131], v[88:91], v[64:67]
  ds_read_b64_tr_b16 v[112:113], v20 offset:46080
  v_mfma_f32_16x16x32_bf16 v[76:79], a[132:135], v[88:91], v[76:79]
  s_add_u32 m0, s60, 20480
  ds_read_b64_tr_b16 v[114:115], v20 offset:47360
  buffer_load_dwordx4 v248, s[16:19], s34 offen lds
  v_mfma_f32_16x16x32_bf16 v[68:71], a[128:131], v[92:95], v[68:71]
  ds_read_b64_tr_b16 v[116:117], v20 offset:46120
  v_mfma_f32_16x16x32_bf16 v[80:83], a[132:135], v[92:95], v[80:83]
  ds_read_b64_tr_b16 v[118:119], v20 offset:47400
  v_mfma_f32_16x16x32_bf16 v[72:75], a[128:131], v[96:99], v[72:75]
  ds_read_b64_tr_b16 v[120:121], v21 offset:46080
  v_mfma_f32_16x16x32_bf16 v[84:87], a[132:135], v[96:99], v[84:87]
  ds_read_b64_tr_b16 v[122:123], v21 offset:47360
  s_waitcnt lgkmcnt(6)
  v_mfma_f32_16x16x32_bf16 v[64:67], a[136:139], v[100:103], v[64:67]
  ds_read_b64_tr_b16 v[124:125], v20 offset:48640
  v_mfma_f32_16x16x32_bf16 v[76:79], a[140:143], v[100:103], v[76:79]
  ds_read_b64_tr_b16 v[126:127], v20 offset:49920
  v_mfma_f32_16x16x32_bf16 v[68:71], a[136:139], v[104:107], v[68:71]
  ds_read_b64_tr_b16 v[128:129], v20 offset:48680
  v_mfma_f32_16x16x32_bf16 v[80:83], a[140:143], v[104:107], v[80:83]
  ds_read_b64_tr_b16 v[130:131], v20 offset:49960
  v_mfma_f32_16x16x32_bf16 v[72:75], a[136:139], v[108:111], v[72:75]
  ds_read_b64_tr_b16 v[132:133], v21 offset:48640
  v_mfma_f32_16x16x32_bf16 v[84:87], a[140:143], v[108:111], v[84:87]
  ds_read_b64_tr_b16 v[134:135], v21 offset:49920
  s_waitcnt lgkmcnt(6)
  v_mfma_f32_16x16x32_bf16 v[64:67], a[144:147], v[112:115], v[64:67]
  s_add_u32 m0, s60, 21504
  v_mfma_f32_16x16x32_bf16 v[76:79], a[148:151], v[112:115], v[76:79]
  buffer_load_dwordx4 v249, s[16:19], s34 offen lds
  v_mfma_f32_16x16x32_bf16 v[68:71], a[144:147], v[116:119], v[68:71]
  v_mfma_f32_16x16x32_bf16 v[80:83], a[148:151], v[116:119], v[80:83]
  v_mfma_f32_16x16x32_bf16 v[72:75], a[144:147], v[120:123], v[72:75]
  v_mfma_f32_16x16x32_bf16 v[84:87], a[148:151], v[120:123], v[84:87]
  s_waitcnt lgkmcnt(0)
  v_mfma_f32_16x16x32_bf16 v[64:67], a[152:155], v[124:127], v[64:67]
  v_mfma_f32_16x16x32_bf16 v[76:79], a[156:159], v[124:127], v[76:79]
  v_mfma_f32_16x16x32_bf16 v[68:71], a[152:155], v[128:131], v[68:71]
  v_mfma_f32_16x16x32_bf16 v[80:83], a[156:159], v[128:131], v[80:83]
  v_mfma_f32_16x16x32_bf16 v[72:75], a[152:155], v[132:135], v[72:75]
  v_mfma_f32_16x16x32_bf16 v[84:87], a[156:159], v[132:135], v[84:87]
  v_mov_b32 v56, 0x3f803f80
  v_cmp_gt_u32 vcc, 210, v0
  s_nop 1
  s_mov_b64 s[96:97], vcc
  s_nop 1
  v_cvt_pk_bf16_f32 v144, v72, v73
  v_cvt_pk_bf16_f32 v145, v74, v75
  v_cvt_pk_bf16_f32 v146, v84, v85
  v_cvt_pk_bf16_f32 v147, v86, v87
  v_cndmask_b32 v144, v144, v56, s[0:1]
  v_cndmask_b32 v145, v145, v56, s[0:1]
  v_cndmask_b32 v146, v146, v56, s[0:1]
  v_cndmask_b32 v147, v147, v56, s[0:1]
  ds_write_b128 v10, v[144:147] offset:2048
  v_cvt_pk_bf16_f32 v136, v64, v65
  v_cvt_pk_bf16_f32 v137, v66, v67
  v_cvt_pk_bf16_f32 v138, v76, v77
  v_cvt_pk_bf16_f32 v139, v78, v79
  ds_write_b128 v10, v[136:139] offset:0
  v_cvt_pk_bf16_f32 v140, v68, v69
  v_cvt_pk_bf16_f32 v141, v70, v71
  v_cvt_pk_bf16_f32 v142, v80, v81
  v_cvt_pk_bf16_f32 v143, v82, v83
  ds_write_b128 v10, v[140:143] offset:1024
  s_waitcnt lgkmcnt(0)
  s_barrier
  ds_read_b128 v[216:219], v11 offset:0
  ds_read_b64_tr_b16 v[168:169], v25 offset:0
  ds_read_b64_tr_b16 v[170:171], v25 offset:2560
  ds_read_b64_tr_b16 v[172:173], v25 offset:32
  ds_read_b64_tr_b16 v[174:175], v25 offset:2592
  ds_read_b64_tr_b16 v[176:177], v25 offset:64
  ds_read_b64_tr_b16 v[178:179], v25 offset:2624
  ds_read_b128 v[220:223], v11 offset:3072
  ds_read_b64_tr_b16 v[180:181], v25 offset:5120
  ds_read_b64_tr_b16 v[182:183], v25 offset:7680
  ds_read_b64_tr_b16 v[184:185], v25 offset:5152
  ds_read_b64_tr_b16 v[186:187], v25 offset:7712
  ds_read_b64_tr_b16 v[188:189], v25 offset:5184
  ds_read_b64_tr_b16 v[190:191], v25 offset:7744
  ds_read_b128 v[224:227], v11 offset:6144
  ds_read_b64_tr_b16 v[192:193], v25 offset:10240
  ds_read_b64_tr_b16 v[194:195], v25 offset:12800
  ds_read_b64_tr_b16 v[196:197], v25 offset:10272
  ds_read_b64_tr_b16 v[198:199], v25 offset:12832
  ds_read_b64_tr_b16 v[200:201], v25 offset:10304
  ds_read_b64_tr_b16 v[202:203], v25 offset:12864
  ds_read_b128 v[228:231], v11 offset:9216
  ds_read_b64_tr_b16 v[204:205], v25 offset:15360
  ds_read_b64_tr_b16 v[206:207], v25 offset:17920
  ds_read_b64_tr_b16 v[208:209], v25 offset:15392
  ds_read_b64_tr_b16 v[210:211], v25 offset:17952
  ds_read_b64_tr_b16 v[212:213], v25 offset:15424
  ds_read_b64_tr_b16 v[214:215], v25 offset:17984
  s_waitcnt lgkmcnt(15)
  v_mfma_f32_16x16x32_bf16 v[148:151], v[168:171], v[216:219], 0
  v_mfma_f32_16x16x32_bf16 v[152:155], v[172:175], v[216:219], 0
  v_mfma_f32_16x16x32_bf16 v[156:159], v[176:179], v[216:219], 0
  s_waitcnt lgkmcnt(14)
  v_mfma_f32_16x16x32_bf16 v[148:151], v[180:183], v[220:223], v[148:151]
  v_mfma_f32_16x16x32_bf16 v[152:155], v[184:187], v[220:223], v[152:155]
  v_mfma_f32_16x16x32_bf16 v[156:159], v[188:191], v[220:223], v[156:159]
  s_waitcnt lgkmcnt(7)
  v_mfma_f32_16x16x32_bf16 v[148:151], v[192:195], v[224:227], v[148:151]
  v_mfma_f32_16x16x32_bf16 v[152:155], v[196:199], v[224:227], v[152:155]
  v_mfma_f32_16x16x32_bf16 v[156:159], v[200:203], v[224:227], v[156:159]
  s_waitcnt lgkmcnt(0)
  v_mfma_f32_16x16x32_bf16 v[148:151], v[204:207], v[228:231], v[148:151]
  v_mfma_f32_16x16x32_bf16 v[152:155], v[208:211], v[228:231], v[152:155]
  v_mfma_f32_16x16x32_bf16 v[156:159], v[212:215], v[228:231], v[156:159]
  s_nop 5
  v_cvt_pk_bf16_f32 v136, v148, v149
  v_cvt_pk_bf16_f32 v137, v150, v151
  ds_write_b64 v12, v[136:137] offset:0
  v_cvt_pk_bf16_f32 v138, v152, v153
  v_cvt_pk_bf16_f32 v139, v154, v155
  ds_write_b64 v12, v[138:139] offset:32
  v_cvt_pk_bf16_f32 v140, v156, v157
  v_cvt_pk_bf16_f32 v141, v158, v159
  ds_write_b64 v13, v[140:141] offset:64
  s_waitcnt lgkmcnt(0)
  s_barrier
  ds_read_b128 v[160:163], v14
  s_waitcnt lgkmcnt(0)
  v_cndmask_b32 v160, 0, v160, s[96:97]
  v_cndmask_b32 v161, 0, v161, s[96:97]
  v_cndmask_b32 v162, 0, v162, s[96:97]
  v_cndmask_b32 v163, 0, v163, s[96:97]
  buffer_store_dwordx4 v[160:163], v28, s[36:39], 0 offen sc1
  s_add_u32 m0, s60, 22528
  s_nop 0
  buffer_load_dwordx4 v250, s[16:19], s34 offen lds
  s_add_u32 m0, s60, 23552
  s_nop 0
  buffer_load_dwordx4 v251, s[16:19], s34 offen lds
  s_add_u32 m0, s60, 24576
  s_nop 0
  buffer_load_dwordx4 v252, s[16:19], s34 offen lds
  s_waitcnt vmcnt(6)
  s_barrier
  ds_read_b64_tr_b16 v[88:89], v18 offset:0
  ds_read_b64_tr_b16 v[90:91], v18 offset:1280
  ds_read_b64_tr_b16 v[92:93], v18 offset:8
  ds_read_b64_tr_b16 v[94:95], v18 offset:1288
  ds_read_b64_tr_b16 v[96:97], v19 offset:0
  ds_read_b64_tr_b16 v[98:99], v19 offset:1280
  ds_read_b64_tr_b16 v[100:101], v18 offset:2560
  ds_read_b64_tr_b16 v[102:103], v18 offset:3840
  ds_read_b64_tr_b16 v[104:105], v18 offset:2568
  ds_read_b64_tr_b16 v[106:107], v18 offset:3848
  ds_read_b64_tr_b16 v[108:109], v19 offset:2560
  ds_read_b64_tr_b16 v[110:111], v19 offset:3840
  s_waitcnt lgkmcnt(6)
  v_mfma_f32_16x16x32_bf16 v[64:67], v[88:91], a[0:3], 0
  ds_read_b64_tr_b16 v[112:113], v18 offset:5120
  v_mfma_f32_16x16x32_bf16 v[76:79], v[88:91], a[4:7], 0
  ds_read_b64_tr_b16 v[114:115], v18 offset:6400
  buffer_load_dwordx4 v[52:55], v30, s[36:39], 0 offen sc1
  v_mfma_f32_16x16x32_bf16 v[68:71], v[92:95], a[0:3], 0
  ds_read_b64_tr_b16 v[116:117], v18 offset:5128
  v_mfma_f32_16x16x32_bf16 v[80:83], v[92:95], a[4:7], 0
  ds_read_b64_tr_b16 v[118:119], v18 offset:6408
  v_mfma_f32_16x16x32_bf16 v[72:75], v[96:99], a[0:3], 0
  ds_read_b64_tr_b16 v[120:121], v19 offset:5120
  v_mfma_f32_16x16x32_bf16 v[84:87], v[96:99], a[4:7], 0
  ds_read_b64_tr_b16 v[122:123], v19 offset:6400
  s_waitcnt lgkmcnt(6)
  v_mfma_f32_16x16x32_bf16 v[64:67], v[100:103], a[8:11], v[64:67]
  ds_read_b64_tr_b16 v[124:125], v18 offset:7680
  v_mfma_f32_16x16x32_bf16 v[76:79], v[100:103], a[12:15], v[76:79]
  ds_read_b64_tr_b16 v[126:127], v18 offset:8960
  s_cmp_ge_u32 s40, 2
  s_cbranch_scc1 L_skg_Q2_0
  s_add_u32 m0, s60, 40960
  s_nop 0
  buffer_load_dwordx4 v248, s[16:19], s35 offen lds
L_skg_Q2_0:
  v_mfma_f32_16x16x32_bf16 v[68:71], v[104:107], a[8:11], v[68:71]
  ds_read_b64_tr_b16 v[128:129], v18 offset:7688
  v_mfma_f32_16x16x32_bf16 v[80:83], v[104:107], a[12:15], v[80:83]
  ds_read_b64_tr_b16 v[130:131], v18 offset:8968
  v_mfma_f32_16x16x32_bf16 v[72:75], v[108:111], a[8:11], v[72:75]
  ds_read_b64_tr_b16 v[132:133], v19 offset:7680
  v_mfma_f32_16x16x32_bf16 v[84:87], v[108:111], a[12:15], v[84:87]
  ds_read_b64_tr_b16 v[134:135], v19 offset:8960
  s_waitcnt lgkmcnt(6)
  v_mfma_f32_16x16x32_bf16 v[64:67], v[112:115], a[16:19], v[64:67]
  ds_read_b64_tr_b16 v[88:89], v18 offset:10240
  v_mfma_f32_16x16x32_bf16 v[76:79], v[112:115], a[20:23], v[76:79]
  ds_read_b64_tr_b16 v[90:91], v18 offset:11520
  s_cmp_ge_u32 s40, 2
  s_cbranch_scc1 L_skg_Q2_1
  s_add_u32 m0, s60, 41984
  s_nop 0
  buffer_load_dwordx4 v249, s[16:19], s35 offen lds
L_skg_Q2_1:
  v_mfma_f32_16x16x32_bf16 v[68:71], v[116:119], a[16:19], v[68:71]
  ds_read_b64_tr_b16 v[92:93], v18 offset:10248
  v_mfma_f32_16x16x32_bf16 v[80:83], v[116:119], a[20:23], v[80:83]
  ds_read_b64_tr_b16 v[94:95], v18 offset:11528
  v_mfma_f32_16x16x32_bf16 v[72:75], v[120:123], a[16:19], v[72:75]
  ds_read_b64_tr_b16 v[96:97], v19 offset:10240
  v_mfma_f32_16x16x32_bf16 v[84:87], v[120:123], a[20:23], v[84:87]
  ds_read_b64_tr_b16 v[98:99], v19 offset:11520
  s_waitcnt lgkmcnt(6)
  v_mfma_f32_16x16x32_bf16 v[64:67], v[124:127], a[24:27], v[64:67]
  ds_read_b64_tr_b16 v[100:101], v18 offset:12800
  v_mfma_f32_16x16x32_bf16 v[76:79], v[124:127], a[28:31], v[76:79]
  ds_read_b64_tr_b16 v[102:103], v18 offset:14080
  s_cmp_ge_u32 s40, 2
  s_cbranch_scc1 L_skg_Q2_2
  s_add_u32 m0, s60, 43008
  s_nop 0
  buffer_load_dwordx4 v250, s[16:19], s35 offen lds
L_skg_Q2_2:
  v_mfma_f32_16x16x32_bf16 v[68:71], v[128:131], a[24:27], v[68:71]
  ds_read_b64_tr_b16 v[104:105], v18 offset:12808
  v_mfma_f32_16x16x32_bf16 v[80:83], v[128:131], a[28:31], v[80:83]
  ds_read_b64_tr_b16 v[106:107], v18 offset:14088
  v_mfma_f32_16x16x32_bf16 v[72:75], v[132:135], a[24:27], v[72:75]
  ds_read_b64_tr_b16 v[108:109], v19 offset:12800
  v_mfma_f32_16x16x32_bf16 v[84:87], v[132:135], a[28:31], v[84:87]
  ds_read_b64_tr_b16 v[110:111], v19 offset:14080
  s_waitcnt lgkmcnt(6)
  v_mfma_f32_16x16x32_bf16 v[64:67], v[88:91], a[32:35], v[64:67]
  ds_read_b64_tr_b16 v[112:113], v18 offset:15360
  v_mfma_f32_16x16x32_bf16 v[76:79], v[88:91], a[36:39], v[76:79]
  ds_read_b64_tr_b16 v[114:115], v18 offset:16640
  s_cmp_ge_u32 s40, 2
  s_cbranch_scc1 L_skg_Q2_3
  s_add_u32 m0, s60, 44032
  s_nop 0
  buffer_load_dwordx4 v251, s[16:19], s35 offen lds
L_skg_Q2_3:
  v_mfma_f32_16x16x32_bf16 v[68:71], v[92:95], a[32:35], v[68:71]
  ds_read_b64_tr_b16 v[116:117], v18 offset:15368
  v_mfma_f32_16x16x32_bf16 v[80:83], v[92:95], a[36:39], v[80:83]
  ds_read_b64_tr_b16 v[118:119], v18 offset:16648
  v_mfma_f32_16x16x32_bf16 v[72:75], v[96:99], a[32:35], v[72:75]
  ds_read_b64_tr_b16 v[120:121], v19 offset:15360
  v_mfma_f32_16x16x32_bf16 v[84:87], v[96:99], a[36:39], v[84:87]
  ds_read_b64_tr_b16 v[122:123], v19 offset:16640
  s_waitcnt lgkmcnt(6)
  v_mfma_f32_16x16x32_bf16 v[64:67], v[100:103], a[40:43], v[64:67]
  ds_read_b64_tr_b16 v[124:125], v18 offset:17920
  v_mfma_f32_16x16x32_bf16 v[76:79], v[100:103], a[44:47], v[76:79]
  ds_read_b64_tr_b16 v[126:127], v18 offset:19200
  s_cmp_ge_u32 s40, 2
  s_cbranch_scc1 L_skg_Q2_4
  s_add_u32 m0, s60, 45056
  s_nop 0
  buffer_load_dwordx4 v252, s[16:19], s35 offen lds
L_skg_Q2_4:
  v_mfma_f32_16x16x32_bf16 v[68:71], v[104:107], a[40:43], v[68:71]
  ds_read_b64_tr_b16 v[128:129], v18 offset:17928
  v_mfma_f32_16x16x32_bf16 v[80:83], v[104:107], a[44:47], v[80:83]
  ds_read_b64_tr_b16 v[130:131], v18 offset:19208
  v_mfma_f32_16x16x32_bf16 v[72:75], v[108:111], a[40:43], v[72:75]
  ds_read_b64_tr_b16 v[132:133], v19 offset:17920
  v_mfma_f32_16x16x32_bf16 v[84:87], v[108:111], a[44:47], v[84:87]
  ds_read_b64_tr_b16 v[134:135], v19 offset:19200
  s_waitcnt vmcnt(1)
  s_barrier
  s_waitcnt lgkmcnt(6)
  v_mfma_f32_16x16x32_bf16 v[64:67], v[112:115], a[48:51], v[64:67]
  ds_read_b64_tr_b16 v[88:89], v18 offset:20480
  v_mfma_f32_16x16x32_bf16 v[76:79], v[112:115], a[52:55], v[76:79]
  ds_read_b64_tr_b16 v[90:91], v18 offset:21760
  s_mul_i32 s63, s40, 40960
  s_add_u32 s63, s63, 655360
  s_add_u32 m0, s60, 133120
  s_nop 0
  buffer_load_dwordx4 v8, s[24:27], s63 offen lds
  v_mfma_f32_16x16x32_bf16 v[68:71], v[116:119], a[48:51], v[68:71]
  ds_read_b64_tr_b16 v[92:93], v18 offset:20488
  v_mfma_f32_16x16x32_bf16 v[80:83], v[116:119], a[52:55], v[80:83]
  ds_read_b64_tr_b16 v[94:95], v18 offset:21768
  v_mfma_f32_16x16x32_bf16 v[72:75], v[120:123], a[48:51], v[72:75]
  ds_read_b64_tr_b16 v[96:97], v19 offset:20480
  v_mfma_f32_16x16x32_bf16 v[84:87], v[120:123], a[52:55], v[84:87]
  ds_read_b64_tr_b16 v[98:99], v19 offset:21760
  s_waitcnt lgkmcnt(6)
  v_mfma_f32_16x16x32_bf16 v[64:67], v[124:127], a[56:59], v[64:67]
  ds_read_b64_tr_b16 v[100:101], v18 offset:23040
  v_mfma_f32_16x16x32_bf16 v[76:79], v[124:127], a[60:63], v[76:79]
  s_add_u32 m0, s60, 134144
  ds_read_b64_tr_b16 v[102:103], v18 offset:24320
  buffer_load_dwordx4 v9, s[24:27], s63 offen lds
  v_mfma_f32_16x16x32_bf16 v[68:71], v[128:131], a[56:59], v[68:71]
  ds_read_b64_tr_b16 v[104:105], v18 offset:23048
  v_mfma_f32_16x16x32_bf16 v[80:83], v[128:131], a[60:63], v[80:83]
  ds_read_b64_tr_b16 v[106:107], v18 offset:24328
  v_mfma_f32_16x16x32_bf16 v[72:75], v[132:135], a[56:59], v[72:75]
  ds_read_b64_tr_b16 v[108:109], v19 offset:23040
  v_mfma_f32_16x16x32_bf16 v[84:87], v[132:135], a[60:63], v[84:87]
  ds_read_b64_tr_b16 v[110:111], v19 offset:24320
  s_waitcnt lgkmcnt(6)
  v_mfma_f32_16x16x32_bf16 v[64:67], v[88:91], a[64:67], v[64:67]
  ds_read_b64_tr_b16 v[112:113], v18 offset:25600
  v_mfma_f32_16x16x32_bf16 v[76:79], v[88:91], a[68:71], v[76:79]
  s_add_u32 m0, s60, 135168
  ds_read_b64_tr_b16 v[114:115], v18 offset:26880
  buffer_load_dwordx4 v49, s[24:27], s63 offen lds
  v_mfma_f32_16x16x32_bf16 v[68:71], v[92:95], a[64:67], v[68:71]
  ds_read_b64_tr_b16 v[116:117], v18 offset:25608
  v_mfma_f32_16x16x32_bf16 v[80:83], v[92:95], a[68:71], v[80:83]
  ds_read_b64_tr_b16 v[118:119], v18 offset:26888
  v_mfma_f32_16x16x32_bf16 v[72:75], v[96:99], a[64:67], v[72:75]
  ds_read_b64_tr_b16 v[120:121], v19 offset:25600
  v_mfma_f32_16x16x32_bf16 v[84:87], v[96:99], a[68:71], v[84:87]
  ds_read_b64_tr_b16 v[122:123], v19 offset:26880
  s_waitcnt lgkmcnt(6)
  v_mfma_f32_16x16x32_bf16 v[64:67], v[100:103], a[72:75], v[64:67]
  ds_read_b64_tr_b16 v[124:125], v18 offset:28160
  v_mfma_f32_16x16x32_bf16 v[76:79], v[100:103], a[76:79], v[76:79]
  s_add_u32 m0, s60, 136192
  ds_read_b64_tr_b16 v[126:127], v18 offset:29440
  buffer_load_dwordx4 v51, s[24:27], s63 offen lds
  v_mfma_f32_16x16x32_bf16 v[68:71], v[104:107], a[72:75], v[68:71]
  ds_read_b64_tr_b16 v[128:129], v18 offset:28168
  v_mfma_f32_16x16x32_bf16 v[80:83], v[104:107], a[76:79], v[80:83]
  ds_read_b64_tr_b16 v[130:131], v18 offset:29448
  v_mfma_f32_16x16x32_bf16 v[72:75], v[108:111], a[72:75], v[72:75]
  ds_read_b64_tr_b16 v[132:133], v19 offset:28160
  v_mfma_f32_16x16x32_bf16 v[84:87], v[108:111], a[76:79], v[84:87]
  ds_read_b64_tr_b16 v[134:135], v19 offset:29440
  s_waitcnt lgkmcnt(6)
  v_mfma_f32_16x16x32_bf16 v[64:67], v[112:115], a[80:83], v[64:67]
  ds_read_b64_tr_b16 v[88:89], v18 offset:30720
  v_mfma_f32_16x16x32_bf16 v[76:79], v[112:115], a[84:87], v[76:79]
  s_add_u32 m0, s60, 137216
  ds_read_b64_tr_b16 v[90:91], v18 offset:32000
  buffer_load_dwordx4 v253, s[24:27], s63 offen lds
  v_mfma_f32_16x16x32_bf16 v[68:71], v[116:119], a[80:83], v[68:71]
  ds_read_b64_tr_b16 v[92:93], v18 offset:30728
  v_mfma_f32_16x16x32_bf16 v[80:83], v[116:119], a[84:87], v[80:83]
  ds_read_b64_tr_b16 v[94:95], v18 offset:32008
  v_mfma_f32_16x16x32_bf16 v[72:75], v[120:123], a[80:83], v[72:75]
  ds_read_b64_tr_b16 v[96:97], v19 offset:30720
  v_mfma_f32_16x16x32_bf16 v[84:87], v[120:123], a[84:87], v[84:87]
  s_mov_b32 s56, 0
  s_waitcnt vmcnt(5)
L_fl_check:
  v_and_b32 v60, v52, v53
  v_and_b32 v61, v54, v55
  v_or_b32 v62, v52, v53
  v_or_b32 v63, v54, v55
  v_and_b32 v60, v60, v61
  v_or_b32 v62, v62, v63
  v_xor_b32 v60, s62, v60
  v_xor_b32 v62, s62, v62
  v_or_b32 v60, v60, v62
  v_cmp_lt_u32 vcc, 15, v60
  s_nop 1
  s_or_b32 s58, vcc_lo, vcc_hi
  s_cmp_eq_u32 s58, 0
  s_cbranch_scc1 L_fl_ok
  s_add_u32 s56, s56, 1
  s_cmp_gt_u32 s56, 20000
  s_cbranch_scc1 L_fl_ok
  buffer_load_dwordx4 v[52:55], v30, s[36:39], 0 offen sc1
  s_waitcnt vmcnt(0)
  s_branch L_fl_check
L_fl_ok:
  s_and_b32 s48, s46, 3
  s_cmp_eq_u32 s48, 1
  s_cselect_b64 vcc, -1, 0
  v_cndmask_b32 v60, v52, v53, vcc
  s_cmp_eq_u32 s48, 2
  s_cselect_b64 vcc, -1, 0
  v_cndmask_b32 v60, v60, v54, vcc
  s_cmp_eq_u32 s48, 3
  s_cselect_b64 vcc, -1, 0
  v_cndmask_b32 v60, v60, v55, vcc
  v_cmp_ne_u32 vcc, s57, v60
  s_lshr_b32 s49, s46, 2
  s_mov_b32 s50, 0x55555555
  s_lshl_b32 s50, s50, s49
  s_or_b32 s51, vcc_lo, vcc_hi
  s_and_b32 s51, s51, s50
  s_cmp_eq_u32 s51, 0
  s_cselect_b32 s3, 1, 0
  ds_read_b64_tr_b16 v[98:99], v19 offset:32000
  s_waitcnt lgkmcnt(6)
  v_mfma_f32_16x16x32_bf16 v[64:67], v[124:127], a[88:91], v[64:67]
  ds_read_b64_tr_b16 v[100:101], v18 offset:33280
  v_mfma_f32_16x16x32_bf16 v[76:79], v[124:127], a[92:95], v[76:79]
  ds_read_b64_tr_b16 v[102:103], v18 offset:34560
  v_mfma_f32_16x16x32_bf16 v[68:71], v[128:131], a[88:91], v[68:71]
  ds_read_b64_tr_b16 v[104:105], v18 offset:33288
  v_mfma_f32_16x16x32_bf16 v[80:83], v[128:131], a[92:95], v[80:83]
  s_mov_b32 s49, 14336
  s_mov_b32 s50, 28672
  s_mov_b32 s51, 43008
  buffer_load_dwordx4 a[0:3], v29, s[36:39], 0 offen offset:0 sc1
  ds_read_b64_tr_b16 v[106:107], v18 offset:34568
  v_mfma_f32_16x16x32_bf16 v[72:75], v[132:135], a[88:91], v[72:75]
  ds_read_b64_tr_b16 v[108:109], v19 offset:33280
  v_mfma_f32_16x16x32_bf16 v[84:87], v[132:135], a[92:95], v[84:87]
  ds_read_b64_tr_b16 v[110:111], v19 offset:34560
  s_waitcnt lgkmcnt(6)
  v_mfma_f32_16x16x32_bf16 v[64:67], v[88:91], a[96:99], v[64:67]
  buffer_load_dwordx4 a[4:7], v29, s[36:39], s49 offen offset:0 sc1
  ds_read_b64_tr_b16 v[112:113], v18 offset:35840
  v_mfma_f32_16x16x32_bf16 v[76:79], v[88:91], a[100:103], v[76:79]
  ds_read_b64_tr_b16 v[114:115], v18 offset:37120
  v_mfma_f32_16x16x32_bf16 v[68:71], v[92:95], a[96:99], v[68:71]
  ds_read_b64_tr_b16 v[116:117], v18 offset:35848
  v_mfma_f32_16x16x32_bf16 v[80:83], v[92:95], a[100:103], v[80:83]
  buffer_load_dwordx4 a[8:11], v29, s[36:39], s50 offen offset:0 sc1
  ds_read_b64_tr_b16 v[118:119], v18 offset:37128
  v_mfma_f32_16x16x32_bf16 v[72:75], v[96:99], a[96:99], v[72:75]
  ds_read_b64_tr_b16 v[120:121], v19 offset:35840
  v_mfma_f32_16x16x32_bf16 v[84:87], v[96:99], a[100:103], v[84:87]
  ds_read_b64_tr_b16 v[122:123], v19 offset:37120
  s_waitcnt lgkmcnt(6)
  v_mfma_f32_16x16x32_bf16 v[64:67], v[100:103], a[104:107], v[64:67]
  buffer_load_dwordx4 a[12:15], v29, s[36:39], s51 offen offset:0 sc1
  ds_read_b64_tr_b16 v[124:125], v18 offset:38400
  v_mfma_f32_16x16x32_bf16 v[76:79], v[100:103], a[108:111], v[76:79]
  ds_read_b64_tr_b16 v[126:127], v18 offset:39680
  v_mfma_f32_16x16x32_bf16 v[68:71], v[104:107], a[104:107], v[68:71]
  ds_read_b64_tr_b16 v[128:129], v18 offset:38408
  v_mfma_f32_16x16x32_bf16 v[80:83], v[104:107], a[108:111], v[80:83]
  buffer_load_dwordx4 a[16:19], v29, s[36:39], 0 offen offset:1024 sc1
  ds_read_b64_tr_b16 v[130:131], v18 offset:39688
  v_mfma_f32_16x16x32_bf16 v[72:75], v[108:111], a[104:107], v[72:75]
  ds_read_b64_tr_b16 v[132:133], v19 offset:38400
  v_mfma_f32_16x16x32_bf16 v[84:87], v[108:111], a[108:111], v[84:87]
  ds_read_b64_tr_b16 v[134:135], v19 offset:39680
  s_waitcnt vmcnt(10)
  s_barrier
  s_waitcnt lgkmcnt(6)
  v_mfma_f32_16x16x32_bf16 v[64:67], v[112:115], a[112:115], v[64:67]
  buffer_load_dwordx4 a[20:23], v29, s[36:39], s49 offen offset:1024 sc1
  ds_read_b64_tr_b16 v[88:89], v18 offset:40960
  v_mfma_f32_16x16x32_bf16 v[76:79], v[112:115], a[116:119], v[76:79]
  ds_read_b64_tr_b16 v[90:91], v18 offset:42240
  v_mfma_f32_16x16x32_bf16 v[68:71], v[116:119], a[112:115], v[68:71]
  ds_read_b64_tr_b16 v[92:93], v18 offset:40968
  v_mfma_f32_16x16x32_bf16 v[80:83], v[116:119], a[116:119], v[80:83]
  buffer_load_dwordx4 a[24:27], v29, s[36:39], s50 offen offset:1024 sc1
  ds_read_b64_tr_b16 v[94:95], v18 offset:42248
  v_mfma_f32_16x16x32_bf16 v[72:75], v[120:123], a[112:115], v[72:75]
  ds_read_b64_tr_b16 v[96:97], v19 offset:40960
  v_mfma_f32_16x16x32_bf16 v[84:87], v[120:123], a[116:119], v[84:87]
  ds_read_b64_tr_b16 v[98:99], v19 offset:42240
  s_waitcnt lgkmcnt(6)
  v_mfma_f32_16x16x32_bf16 v[64:67], v[124:127], a[120:123], v[64:67]
  buffer_load_dwordx4 a[28:31], v29, s[36:39], s51 offen offset:1024 sc1
  ds_read_b64_tr_b16 v[100:101], v18 offset:43520
  v_mfma_f32_16x16x32_bf16 v[76:79], v[124:127], a[124:127], v[76:79]
  ds_read_b64_tr_b16 v[102:103], v18 offset:44800
  v_mfma_f32_16x16x32_bf16 v[68:71], v[128:131], a[120:123], v[68:71]
  ds_read_b64_tr_b16 v[104:105], v18 offset:43528
  v_mfma_f32_16x16x32_bf16 v[80:83], v[128:131], a[124:127], v[80:83]
  buffer_load_dwordx4 a[32:35], v29, s[36:39], 0 offen offset:2048 sc1
  ds_read_b64_tr_b16 v[106:107], v18 offset:44808
  v_mfma_f32_16x16x32_bf16 v[72:75], v[132:135], a[120:123], v[72:75]
  ds_read_b64_tr_b16 v[108:109], v19 offset:43520
  v_mfma_f32_16x16x32_bf16 v[84:87], v[132:135], a[124:127], v[84:87]
  ds_read_b64_tr_b16 v[110:111], v19 offset:44800
  s_waitcnt lgkmcnt(6)
  v_mfma_f32_16x16x32_bf16 v[64:67], v[88:91], a[128:131], v[64:67]
  buffer_load_dwordx4 a[36:39], v29, s[36:39], s49 offen offset:2048 sc1
  ds_read_b64_tr_b16 v[112:113], v18 offset:46080
  v_mfma_f32_16x16x32_bf16 v[76:79], v[88:91], a[132:135], v[76:79]
  ds_read_b64_tr_b16 v[114:115], v18 offset:47360
  v_mfma_f32_16x16x32_bf16 v[68:71], v[92:95], a[128:131], v[68:71]
  ds_read_b64_tr_b16 v[116:117], v18 offset:46088
  v_mfma_f32_16x16x32_bf16 v[80:83], v[92:95], a[132:135], v[80:83]
  buffer_load_dwordx4 a[40:43], v29, s[36:39], s50 offen offset:2048 sc1
  ds_read_b64_tr_b16 v[118:119], v18 offset:47368
  v_mfma_f32_16x16x32_bf16 v[72:75], v[96:99], a[128:131], v[72:75]
  ds_read_b64_tr_b16 v[120:121], v19 offset:46080
  v_mfma_f32_16x16x32_bf16 v[84:87], v[96:99], a[132:135], v[84:87]
  ds_read_b64_tr_b16 v[122:123], v19 offset:47360
  s_waitcnt lgkmcnt(6)
  v_mfma_f32_16x16x32_bf16 v[64:67], v[100:103], a[136:139], v[64:67]
  buffer_load_dwordx4 a[44:47], v29, s[36:39], s51 offen offset:2048 sc1
  ds_read_b64_tr_b16 v[124:125], v18 offset:48640
  v_mfma_f32_16x16x32_bf16 v[76:79], v[100:103], a[140:143], v[76:79]
  ds_read_b64_tr_b16 v[126:127], v18 offset:49920
  v_mfma_f32_16x16x32_bf16 v[68:71], v[104:107], a[136:139], v[68:71]
  ds_read_b64_tr_b16 v[128:129], v18 offset:48648
  v_mfma_f32_16x16x32_bf16 v[80:83], v[104:107], a[140:143], v[80:83]
  s_cmp_ge_u32 s40, 2
  s_cbranch_scc1 L_h1s_h1_0
  buffer_load_dwordx4 a[48:51], v29, s[36:39], 0 offen offset:3072 sc1
L_h1s_h1_0:
  ds_read_b64_tr_b16 v[130:131], v18 offset:49928
  v_mfma_f32_16x16x32_bf16 v[72:75], v[108:111], a[136:139], v[72:75]
  ds_read_b64_tr_b16 v[132:133], v19 offset:48640
  v_mfma_f32_16x16x32_bf16 v[84:87], v[108:111], a[140:143], v[84:87]
  ds_read_b64_tr_b16 v[134:135], v19 offset:49920
  s_waitcnt lgkmcnt(6)
  v_mfma_f32_16x16x32_bf16 v[64:67], v[112:115], a[144:147], v[64:67]
  s_cmp_ge_u32 s40, 2
  s_cbranch_scc1 L_h1s_h1_1
  buffer_load_dwordx4 a[52:55], v29, s[36:39], s49 offen offset:3072 sc1
L_h1s_h1_1:
  v_mfma_f32_16x16x32_bf16 v[76:79], v[112:115], a[148:151], v[76:79]
  v_mfma_f32_16x16x32_bf16 v[68:71], v[116:119], a[144:147], v[68:71]
  v_mfma_f32_16x16x32_bf16 v[80:83], v[116:119], a[148:151], v[80:83]
  s_cmp_ge_u32 s40, 2
  s_cbranch_scc1 L_h1s_h1_2
  buffer_load_dwordx4 a[56:59], v29, s[36:39], s50 offen offset:3072 sc1
L_h1s_h1_2:
  v_mfma_f32_16x16x32_bf16 v[72:75], v[120:123], a[144:147], v[72:75]
  v_mfma_f32_16x16x32_bf16 v[84:87], v[120:123], a[148:151], v[84:87]
  s_waitcnt lgkmcnt(0)
  v_mfma_f32_16x16x32_bf16 v[64:67], v[124:127], a[152:155], v[64:67]
  s_cmp_ge_u32 s40, 2
  s_cbranch_scc1 L_h1s_h1_3
  buffer_load_dwordx4 a[60:63], v29, s[36:39], s51 offen offset:3072 sc1
L_h1s_h1_3:
  v_mfma_f32_16x16x32_bf16 v[76:79], v[124:127], a[156:159], v[76:79]
  v_mfma_f32_16x16x32_bf16 v[68:71], v[128:131], a[152:155], v[68:71]
  v_mfma_f32_16x16x32_bf16 v[80:83], v[128:131], a[156:159], v[80:83]
  v_mfma_f32_16x16x32_bf16 v[72:75], v[132:135], a[152:155], v[72:75]
  v_mfma_f32_16x16x32_bf16 v[84:87], v[132:135], a[156:159], v[84:87]
  v_cvt_pk_bf16_f32 v136, v64, v65
  v_cvt_pk_bf16_f32 v137, v66, v67
  s_nop 2
  v_cvt_pk_bf16_f32 v138, v68, v69
  v_cvt_pk_bf16_f32 v139, v70, v71
  v_cvt_pk_bf16_f32 v140, v76, v77
  v_cvt_pk_bf16_f32 v141, v78, v79
  v_cvt_pk_bf16_f32 v142, v80, v81
  v_cvt_pk_bf16_f32 v143, v82, v83
  v_cvt_pk_bf16_f32 v144, v72, v73
  v_cvt_pk_bf16_f32 v145, v74, v75
  v_cvt_pk_bf16_f32 v146, v84, v85
  v_cvt_pk_bf16_f32 v147, v86, v87
  v_mfma_f32_16x16x32_bf16 v[148:151], a[160:163], v[136:139], 0
  v_mfma_f32_16x16x32_bf16 v[152:155], a[172:175], v[136:139], 0
  v_mfma_f32_16x16x32_bf16 v[156:159], a[184:187], v[136:139], 0
  v_mfma_f32_16x16x32_bf16 v[160:163], a[196:199], v[136:139], 0
  v_mfma_f32_16x16x32_bf16 v[164:167], a[208:211], v[136:139], 0
  s_mul_i32 s63, s40, 40960
  s_add_u32 m0, s60, 51200
  s_nop 0
  buffer_load_dwordx4 v8, s[24:27], s63 offen lds
  v_mfma_f32_16x16x32_bf16 v[148:151], a[164:167], v[140:143], v[148:151]
  v_mfma_f32_16x16x32_bf16 v[152:155], a[176:179], v[140:143], v[152:155]
  v_mfma_f32_16x16x32_bf16 v[156:159], a[188:191], v[140:143], v[156:159]
  v_mfma_f32_16x16x32_bf16 v[160:163], a[200:203], v[140:143], v[160:163]
  v_mfma_f32_16x16x32_bf16 v[164:167], a[212:215], v[140:143], v[164:167]
  v_mfma_f32_16x16x32_bf16 v[148:151], a[168:171], v[144:147], v[148:151]
  v_mfma_f32_16x16x32_bf16 v[152:155], a[180:183], v[144:147], v[152:155]
  v_mfma_f32_16x16x32_bf16 v[156:159], a[192:195], v[144:147], v[156:159]
  v_mfma_f32_16x16x32_bf16 v[160:163], a[204:207], v[144:147], v[160:163]
  v_mfma_f32_16x16x32_bf16 v[164:167], a[216:219], v[144:147], v[164:167]
  s_nop 3
  v_max3_f32 v56, v148, v149, v150
  v_min3_f32 v58, v148, v149, v150
  v_max3_f32 v56, v56, v151, v152
  v_min3_f32 v58, v58, v151, v152
  v_max3_f32 v56, v56, v153, v154
  s_add_u32 m0, s60, 52224
  v_min3_f32 v58, v58, v153, v154
  buffer_load_dwordx4 v9, s[24:27], s63 offen lds
  v_max3_f32 v56, v56, v155, v156
  v_min3_f32 v58, v58, v155, v156
  v_max3_f32 v56, v56, v157, v158
  v_min3_f32 v58, v58, v157, v158
  v_max3_f32 v56, v56, v159, v160
  v_min3_f32 v58, v58, v159, v160
  v_max3_f32 v56, v56, v161, v162
  v_min3_f32 v58, v58, v161, v162
  v_max3_f32 v56, v56, v163, v164
  v_min3_f32 v58, v58, v163, v164
  v_max3_f32 v56, v56, v165, v166
  v_min3_f32 v58, v58, v165, v166
  v_max_f32 v56, v56, v167
  v_min_f32 v58, v58, v167
  s_add_u32 m0, s60, 53248
  v_mul_f32 v56, s55, v56
  buffer_load_dwordx4 v49, s[24:27], s63 offen lds
  v_mul_f32 v58, s55, v58
  s_mov_b32 s48, s55
  s_mov_b32 s49, s55
  v_pk_fma_f32 v[168:169], v[148:149], s[48:49], v[56:57] op_sel_hi:[1,1,0] neg_lo:[0,0,1] neg_hi:[0,0,1]
  v_pk_fma_f32 v[188:189], v[148:149], s[48:49], v[58:59] op_sel_hi:[1,1,0] neg_lo:[1,0,0] neg_hi:[1,0,0]
  v_pk_fma_f32 v[170:171], v[150:151], s[48:49], v[56:57] op_sel_hi:[1,1,0] neg_lo:[0,0,1] neg_hi:[0,0,1]
  v_pk_fma_f32 v[190:191], v[150:151], s[48:49], v[58:59] op_sel_hi:[1,1,0] neg_lo:[1,0,0] neg_hi:[1,0,0]
  v_pk_fma_f32 v[172:173], v[152:153], s[48:49], v[56:57] op_sel_hi:[1,1,0] neg_lo:[0,0,1] neg_hi:[0,0,1]
  v_pk_fma_f32 v[192:193], v[152:153], s[48:49], v[58:59] op_sel_hi:[1,1,0] neg_lo:[1,0,0] neg_hi:[1,0,0]
  v_pk_fma_f32 v[174:175], v[154:155], s[48:49], v[56:57] op_sel_hi:[1,1,0] neg_lo:[0,0,1] neg_hi:[0,0,1]
  v_pk_fma_f32 v[194:195], v[154:155], s[48:49], v[58:59] op_sel_hi:[1,1,0] neg_lo:[1,0,0] neg_hi:[1,0,0]
  v_pk_fma_f32 v[176:177], v[156:157], s[48:49], v[56:57] op_sel_hi:[1,1,0] neg_lo:[0,0,1] neg_hi:[0,0,1]
  v_pk_fma_f32 v[196:197], v[156:157], s[48:49], v[58:59] op_sel_hi:[1,1,0] neg_lo:[1,0,0] neg_hi:[1,0,0]
  v_pk_fma_f32 v[178:179], v[158:159], s[48:49], v[56:57] op_sel_hi:[1,1,0] neg_lo:[0,0,1] neg_hi:[0,0,1]
  v_pk_fma_f32 v[198:199], v[158:159], s[48:49], v[58:59] op_sel_hi:[1,1,0] neg_lo:[1,0,0] neg_hi:[1,0,0]
  s_add_u32 m0, s60, 54272
  v_pk_fma_f32 v[180:181], v[160:161], s[48:49], v[56:57] op_sel_hi:[1,1,0] neg_lo:[0,0,1] neg_hi:[0,0,1]
  buffer_load_dwordx4 v51, s[24:27], s63 offen lds
  v_pk_fma_f32 v[200:201], v[160:161], s[48:49], v[58:59] op_sel_hi:[1,1,0] neg_lo:[1,0,0] neg_hi:[1,0,0]
  v_pk_fma_f32 v[182:183], v[162:163], s[48:49], v[56:57] op_sel_hi:[1,1,0] neg_lo:[0,0,1] neg_hi:[0,0,1]
  v_pk_fma_f32 v[202:203], v[162:163], s[48:49], v[58:59] op_sel_hi:[1,1,0] neg_lo:[1,0,0] neg_hi:[1,0,0]
  v_pk_fma_f32 v[184:185], v[164:165], s[48:49], v[56:57] op_sel_hi:[1,1,0] neg_lo:[0,0,1] neg_hi:[0,0,1]
  v_pk_fma_f32 v[204:205], v[164:165], s[48:49], v[58:59] op_sel_hi:[1,1,0] neg_lo:[1,0,0] neg_hi:[1,0,0]
  v_pk_fma_f32 v[186:187], v[166:167], s[48:49], v[56:57] op_sel_hi:[1,1,0] neg_lo:[0,0,1] neg_hi:[0,0,1]
  v_pk_fma_f32 v[206:207], v[166:167], s[48:49], v[58:59] op_sel_hi:[1,1,0] neg_lo:[1,0,0] neg_hi:[1,0,0]
  v_exp_f32 v168, v168
  v_exp_f32 v169, v169
  v_exp_f32 v170, v170
  v_exp_f32 v171, v171
  v_exp_f32 v172, v172
  v_exp_f32 v173, v173
  v_exp_f32 v174, v174
  s_add_u32 m0, s60, 55296
  v_exp_f32 v175, v175
  buffer_load_dwordx4 v253, s[24:27], s63 offen lds
  v_exp_f32 v176, v176
  v_exp_f32 v177, v177
  v_exp_f32 v178, v178
  v_exp_f32 v179, v179
  v_exp_f32 v180, v180
  v_exp_f32 v181, v181
  v_exp_f32 v182, v182
  v_exp_f32 v183, v183
  v_exp_f32 v184, v184
  v_exp_f32 v185, v185
  v_exp_f32 v186, v186
  v_exp_f32 v187, v187
  v_exp_f32 v188, v188
  v_exp_f32 v189, v189
  v_exp_f32 v190, v190
  v_exp_f32 v191, v191
  s_mul_i32 s63, s40, 40960
  s_add_u32 s63, s63, 163840
  s_add_u32 m0, s60, 71680
  s_nop 0
  buffer_load_dwordx4 v8, s[24:27], s63 offen lds
  v_exp_f32 v192, v192
  v_exp_f32 v193, v193
  v_exp_f32 v194, v194
  v_exp_f32 v195, v195
  v_exp_f32 v196, v196
  v_exp_f32 v197, v197
  v_exp_f32 v198, v198
  v_exp_f32 v199, v199
  v_exp_f32 v200, v200
  v_exp_f32 v201, v201
  v_exp_f32 v202, v202
  v_exp_f32 v203, v203
  v_exp_f32 v204, v204
  v_exp_f32 v205, v205
  s_add_u32 m0, s60, 72704
  v_exp_f32 v206, v206
  buffer_load_dwordx4 v9, s[24:27], s63 offen lds
  v_exp_f32 v207, v207
  v_pk_add_f32 v[60:61], v[168:169], v[170:171]
  v_pk_add_f32 v[62:63], v[188:189], v[190:191]
  v_pk_add_f32 v[60:61], v[60:61], v[172:173]
  v_pk_add_f32 v[62:63], v[62:63], v[192:193]
  v_pk_add_f32 v[60:61], v[60:61], v[174:175]
  v_pk_add_f32 v[62:63], v[62:63], v[194:195]
  v_pk_add_f32 v[60:61], v[60:61], v[176:177]
  v_pk_add_f32 v[62:63], v[62:63], v[196:197]
  v_pk_add_f32 v[60:61], v[60:61], v[178:179]
  v_pk_add_f32 v[62:63], v[62:63], v[198:199]
  v_pk_add_f32 v[60:61], v[60:61], v[180:181]
  v_pk_add_f32 v[62:63], v[62:63], v[200:201]
  v_pk_add_f32 v[60:61], v[60:61], v[182:183]
  v_pk_add_f32 v[62:63], v[62:63], v[202:203]
  s_add_u32 m0, s60, 73728
  v_pk_add_f32 v[60:61], v[60:61], v[184:185]
  buffer_load_dwordx4 v49, s[24:27], s63 offen lds
  v_pk_add_f32 v[62:63], v[62:63], v[204:205]
  v_pk_add_f32 v[60:61], v[60:61], v[186:187]
  v_pk_add_f32 v[62:63], v[62:63], v[206:207]
  v_add_f32 v60, v60, v61
  v_add_f32 v62, v62, v63
  v_rcp_f32 v60, v60
  v_rcp_f32 v62, v62
  v_pk_mul_f32 v[168:169], v[168:169], v[60:61] op_sel_hi:[1,0]
  v_pk_mul_f32 v[188:189], v[188:189], v[62:63] op_sel_hi:[1,0]
  v_pk_mul_f32 v[170:171], v[170:171], v[60:61] op_sel_hi:[1,0]
  v_pk_mul_f32 v[190:191], v[190:191], v[62:63] op_sel_hi:[1,0]
  v_pk_mul_f32 v[172:173], v[172:173], v[60:61] op_sel_hi:[1,0]
  v_pk_mul_f32 v[192:193], v[192:193], v[62:63] op_sel_hi:[1,0]
  v_pk_mul_f32 v[174:175], v[174:175], v[60:61] op_sel_hi:[1,0]
  s_add_u32 m0, s60, 74752
  v_pk_mul_f32 v[194:195], v[194:195], v[62:63] op_sel_hi:[1,0]
  buffer_load_dwordx4 v51, s[24:27], s63 offen lds
  v_pk_mul_f32 v[176:177], v[176:177], v[60:61] op_sel_hi:[1,0]
  v_pk_mul_f32 v[196:197], v[196:197], v[62:63] op_sel_hi:[1,0]
  v_pk_mul_f32 v[178:179], v[178:179], v[60:61] op_sel_hi:[1,0]
  v_pk_mul_f32 v[198:199], v[198:199], v[62:63] op_sel_hi:[1,0]
  v_pk_mul_f32 v[180:181], v[180:181], v[60:61] op_sel_hi:[1,0]
  v_pk_mul_f32 v[200:201], v[200:201], v[62:63] op_sel_hi:[1,0]
  v_pk_mul_f32 v[182:183], v[182:183], v[60:61] op_sel_hi:[1,0]
  v_pk_mul_f32 v[202:203], v[202:203], v[62:63] op_sel_hi:[1,0]
  v_pk_mul_f32 v[184:185], v[184:185], v[60:61] op_sel_hi:[1,0]
  v_pk_mul_f32 v[204:205], v[204:205], v[62:63] op_sel_hi:[1,0]
  v_pk_mul_f32 v[186:187], v[186:187], v[60:61] op_sel_hi:[1,0]
  v_pk_mul_f32 v[206:207], v[206:207], v[62:63] op_sel_hi:[1,0]
  v_cvt_pk_bf16_f32 v208, v168, v169
  v_cvt_pk_bf16_f32 v209, v170, v171
  v_cvt_pk_bf16_f32 v210, v172, v173
  s_add_u32 m0, s60, 75776
  v_cvt_pk_bf16_f32 v211, v174, v175
  buffer_load_dwordx4 v253, s[24:27], s63 offen lds
  v_cvt_pk_bf16_f32 v212, v176, v177
  v_cvt_pk_bf16_f32 v213, v178, v179
  v_cvt_pk_bf16_f32 v214, v180, v181
  v_cvt_pk_bf16_f32 v215, v182, v183
  v_cvt_pk_bf16_f32 v216, v184, v185
  v_cvt_pk_bf16_f32 v217, v186, v187
  v_cvt_pk_bf16_f32 v218, v188, v189
  v_cvt_pk_bf16_f32 v219, v190, v191
  v_cvt_pk_bf16_f32 v220, v192, v193
  v_cvt_pk_bf16_f32 v221, v194, v195
  v_cvt_pk_bf16_f32 v222, v196, v197
  v_cvt_pk_bf16_f32 v223, v198, v199
  v_cvt_pk_bf16_f32 v224, v200, v201
  v_cvt_pk_bf16_f32 v225, v202, v203
  v_cvt_pk_bf16_f32 v226, v204, v205
  v_cvt_pk_bf16_f32 v227, v206, v207
  s_mov_b32 s56, 0
  s_waitcnt vmcnt(10)
L_h1_check:
  s_cmp_lt_u32 s40, 2
  s_cbranch_scc1 L_h1_nozero
  v_accvgpr_write_b32 a48, 0
  v_accvgpr_write_b32 a49, 0
  v_accvgpr_write_b32 a50, 0
  v_accvgpr_write_b32 a51, 0
  v_accvgpr_write_b32 a52, 0
  v_accvgpr_write_b32 a53, 0
  v_accvgpr_write_b32 a54, 0
  v_accvgpr_write_b32 a55, 0
  v_accvgpr_write_b32 a56, 0
  v_accvgpr_write_b32 a57, 0
  v_accvgpr_write_b32 a58, 0
  v_accvgpr_write_b32 a59, 0
  v_accvgpr_write_b32 a60, 0
  v_accvgpr_write_b32 a61, 0
  v_accvgpr_write_b32 a62, 0
  v_accvgpr_write_b32 a63, 0
  s_nop 1
L_h1_nozero:
  v_mfma_f32_16x16x32_bf16 v[88:91], v[32:35], a[0:3], 0
  v_mfma_f32_16x16x32_bf16 v[92:95], v[32:35], a[16:19], 0
  v_mfma_f32_16x16x32_bf16 v[96:99], v[32:35], a[32:35], 0
  v_mfma_f32_16x16x32_bf16 v[100:103], v[32:35], a[48:51], 0
  v_mfma_f32_16x16x32_bf16 v[88:91], v[32:35], a[4:7], v[88:91]
  v_mfma_f32_16x16x32_bf16 v[92:95], v[32:35], a[20:23], v[92:95]
  v_mfma_f32_16x16x32_bf16 v[96:99], v[32:35], a[36:39], v[96:99]
  v_mfma_f32_16x16x32_bf16 v[100:103], v[32:35], a[52:55], v[100:103]
  v_mfma_f32_16x16x32_bf16 v[88:91], v[32:35], a[8:11], v[88:91]
  v_mfma_f32_16x16x32_bf16 v[92:95], v[32:35], a[24:27], v[92:95]
  v_mfma_f32_16x16x32_bf16 v[96:99], v[32:35], a[40:43], v[96:99]
  v_mfma_f32_16x16x32_bf16 v[100:103], v[32:35], a[56:59], v[100:103]
  v_mfma_f32_16x16x32_bf16 v[88:91], v[32:35], a[12:15], v[88:91]
  v_mfma_f32_16x16x32_bf16 v[92:95], v[32:35], a[28:31], v[92:95]
  v_mfma_f32_16x16x32_bf16 v[96:99], v[32:35], a[44:47], v[96:99]
  v_mfma_f32_16x16x32_bf16 v[100:103], v[32:35], a[60:63], v[100:103]
  s_nop 7
  v_pk_add_f32 v[56:57], v[88:89], v[90:91]
  v_pk_add_f32 v[58:59], v[92:93], v[94:95]
  v_pk_add_f32 v[56:57], v[56:57], v[96:97]
  v_pk_add_f32 v[58:59], v[58:59], v[98:99]
  v_pk_add_f32 v[56:57], v[56:57], v[100:101]
  v_pk_add_f32 v[58:59], v[58:59], v[102:103]
  v_pk_add_f32 v[56:57], v[56:57], v[58:59]
  v_cmp_u_f32 vcc, v56, v57
  s_nop 1
  s_or_b32 s58, vcc_lo, vcc_hi
  s_cmp_eq_u32 s58, 0
  s_cbranch_scc1 L_h1_ok
  s_add_u32 s56, s56, 1
  s_cmp_gt_u32 s56, 5000
  s_cbranch_scc1 L_h1_ok
  s_mov_b32 s49, 14336
  s_mov_b32 s50, 28672
  s_mov_b32 s51, 43008
  buffer_load_dwordx4 a[0:3], v29, s[36:39], 0 offen offset:0 sc1
  buffer_load_dwordx4 a[4:7], v29, s[36:39], s49 offen offset:0 sc1
  buffer_load_dwordx4 a[8:11], v29, s[36:39], s50 offen offset:0 sc1
  buffer_load_dwordx4 a[12:15], v29, s[36:39], s51 offen offset:0 sc1
  buffer_load_dwordx4 a[16:19], v29, s[36:39], 0 offen offset:1024 sc1
  buffer_load_dwordx4 a[20:23], v29, s[36:39], s49 offen offset:1024 sc1
  buffer_load_dwordx4 a[24:27], v29, s[36:39], s50 offen offset:1024 sc1
  buffer_load_dwordx4 a[28:31], v29, s[36:39], s51 offen offset:1024 sc1
  buffer_load_dwordx4 a[32:35], v29, s[36:39], 0 offen offset:2048 sc1
  buffer_load_dwordx4 a[36:39], v29, s[36:39], s49 offen offset:2048 sc1
  buffer_load_dwordx4 a[40:43], v29, s[36:39], s50 offen offset:2048 sc1
  buffer_load_dwordx4 a[44:47], v29, s[36:39], s51 offen offset:2048 sc1
  s_cmp_ge_u32 s40, 2
  s_cbranch_scc1 L_h1s_h1r_0
  buffer_load_dwordx4 a[48:51], v29, s[36:39], 0 offen offset:3072 sc1
L_h1s_h1r_0:
  s_cmp_ge_u32 s40, 2
  s_cbranch_scc1 L_h1s_h1r_1
  buffer_load_dwordx4 a[52:55], v29, s[36:39], s49 offen offset:3072 sc1
L_h1s_h1r_1:
  s_cmp_ge_u32 s40, 2
  s_cbranch_scc1 L_h1s_h1r_2
  buffer_load_dwordx4 a[56:59], v29, s[36:39], s50 offen offset:3072 sc1
L_h1s_h1r_2:
  s_cmp_ge_u32 s40, 2
  s_cbranch_scc1 L_h1s_h1r_3
  buffer_load_dwordx4 a[60:63], v29, s[36:39], s51 offen offset:3072 sc1
L_h1s_h1r_3:
  s_waitcnt vmcnt(0)
  s_branch L_h1_check
L_h1_ok:
  v_cvt_pk_bf16_f32 v56, v88, v89
  v_cvt_pk_bf16_f32 v57, v90, v91
  s_mov_b64 exec, 0xffffffff
  ds_write_b64 v31, v[56:57] offset:0
  s_mov_b64 exec, -1
  v_cvt_pk_bf16_f32 v58, v92, v93
  v_cvt_pk_bf16_f32 v59, v94, v95
  s_mov_b64 exec, 0xffffffff
  ds_write_b64 v31, v[58:59] offset:1024
  s_mov_b64 exec, -1
  v_cvt_pk_bf16_f32 v56, v96, v97
  v_cvt_pk_bf16_f32 v57, v98, v99
  s_mov_b64 exec, 0xffffffff
  ds_write_b64 v31, v[56:57] offset:2048
  s_mov_b64 exec, -1
  v_cvt_pk_bf16_f32 v58, v100, v101
  v_cvt_pk_bf16_f32 v59, v102, v103
  s_cmp_ge_u32 s40, 2
  s_cbranch_scc1 L_h1_skipw
  s_mov_b64 exec, 0xffffffff
  ds_write_b64 v31, v[58:59] offset:3072
  s_mov_b64 exec, -1
L_h1_skipw:
  s_mul_i32 s63, s40, 40960
  s_add_u32 s63, s63, 327680
  s_add_u32 m0, s60, 92160
  s_nop 0
  buffer_load_dwordx4 v8, s[24:27], s63 offen lds
  s_add_u32 m0, s60, 93184
  s_nop 0
  buffer_load_dwordx4 v9, s[24:27], s63 offen lds
  s_add_u32 m0, s60, 94208
  s_nop 0
  buffer_load_dwordx4 v49, s[24:27], s63 offen lds
  s_waitcnt lgkmcnt(0)
  s_barrier
  ds_read_b128 a[64:67], v36 offset:0
  ds_read_b128 a[84:87], v36 offset:320
  ds_read_b128 a[104:107], v36 offset:640
  ds_read_b128 a[124:127], v36 offset:960
  ds_read_b128 a[144:147], v37 offset:0
  ds_read_b128 a[164:167], v38 offset:0
  ds_read_b128 a[68:71], v36 offset:16
  ds_read_b128 a[88:91], v36 offset:336
  ds_read_b128 a[108:111], v36 offset:656
  ds_read_b128 a[128:131], v36 offset:976
  ds_read_b128 a[148:151], v37 offset:16
  ds_read_b128 a[168:171], v38 offset:16
  s_waitcnt lgkmcnt(6)
  v_mfma_f32_16x16x32_bf16 v[108:111], a[164:167], v[208:211], 0
  ds_read_b128 a[72:75], v36 offset:32
  v_mfma_f32_16x16x32_bf16 v[88:91], a[64:67], v[208:211], 0
  ds_read_b128 a[92:95], v36 offset:352
  v_mfma_f32_16x16x32_bf16 v[92:95], a[84:87], v[208:211], 0
  ds_read_b128 a[112:115], v36 offset:672
  v_mfma_f32_16x16x32_bf16 v[96:99], a[104:107], v[208:211], 0
  ds_read_b128 a[132:135], v36 offset:992
  v_mfma_f32_16x16x32_bf16 v[100:103], a[124:127], v[208:211], 0
  ds_read_b128 a[152:155], v37 offset:32
  v_mfma_f32_16x16x32_bf16 v[104:107], a[144:147], v[208:211], 0
  s_add_u32 m0, s60, 95232
  ds_read_b128 a[172:175], v38 offset:32
  buffer_load_dwordx4 v51, s[24:27], s63 offen lds
  s_add_u32 m0, s60, 96256
  s_nop 0
  buffer_load_dwordx4 v253, s[24:27], s63 offen lds
  s_waitcnt lgkmcnt(6)
  v_mfma_f32_16x16x32_bf16 v[108:111], a[168:171], v[212:215], v[108:111]
  ds_read_b128 a[76:79], v36 offset:48
  v_mfma_f32_16x16x32_bf16 v[88:91], a[68:71], v[212:215], v[88:91]
  ds_read_b128 a[96:99], v36 offset:368
  v_mfma_f32_16x16x32_bf16 v[92:95], a[88:91], v[212:215], v[92:95]
  ds_read_b128 a[116:119], v36 offset:688
  v_mfma_f32_16x16x32_bf16 v[96:99], a[108:111], v[212:215], v[96:99]
  ds_read_b128 a[136:139], v36 offset:1008
  v_mfma_f32_16x16x32_bf16 v[100:103], a[128:131], v[212:215], v[100:103]
  ds_read_b128 a[156:159], v37 offset:48
  v_mfma_f32_16x16x32_bf16 v[104:107], a[148:151], v[212:215], v[104:107]
  ds_read_b128 a[176:179], v38 offset:48
  s_waitcnt lgkmcnt(6)
  v_mfma_f32_16x16x32_bf16 v[108:111], a[172:175], v[216:219], v[108:111]
  ds_read_b128 a[80:83], v36 offset:64
  v_mfma_f32_16x16x32_bf16 v[88:91], a[72:75], v[216:219], v[88:91]
  ds_read_b128 a[100:103], v36 offset:384
  v_mfma_f32_16x16x32_bf16 v[92:95], a[92:95], v[216:219], v[92:95]
  ds_read_b128 a[120:123], v36 offset:704
  v_mfma_f32_16x16x32_bf16 v[96:99], a[112:115], v[216:219], v[96:99]
  ds_read_b128 a[140:143], v36 offset:1024
  v_mfma_f32_16x16x32_bf16 v[100:103], a[132:135], v[216:219], v[100:103]
  ds_read_b128 a[160:163], v37 offset:64
  v_mfma_f32_16x16x32_bf16 v[104:107], a[152:155], v[216:219], v[104:107]
  ds_read_b128 a[180:183], v38 offset:64
  s_waitcnt lgkmcnt(6)
  v_mfma_f32_16x16x32_bf16 v[108:111], a[176:179], v[220:223], v[108:111]
  v_mfma_f32_16x16x32_bf16 v[88:91], a[76:79], v[220:223], v[88:91]
  v_mfma_f32_16x16x32_bf16 v[92:95], a[96:99], v[220:223], v[92:95]
  v_mfma_f32_16x16x32_bf16 v[96:99], a[116:119], v[220:223], v[96:99]
  v_mfma_f32_16x16x32_bf16 v[100:103], a[136:139], v[220:223], v[100:103]
  v_mfma_f32_16x16x32_bf16 v[104:107], a[156:159], v[220:223], v[104:107]
  s_waitcnt lgkmcnt(0)
  v_mfma_f32_16x16x32_bf16 v[108:111], a[180:183], v[224:227], v[108:111]
  v_mfma_f32_16x16x32_bf16 v[88:91], a[80:83], v[224:227], v[88:91]
  v_mfma_f32_16x16x32_bf16 v[92:95], a[100:103], v[224:227], v[92:95]
  v_mfma_f32_16x16x32_bf16 v[96:99], a[120:123], v[224:227], v[96:99]
  v_mfma_f32_16x16x32_bf16 v[100:103], a[140:143], v[224:227], v[100:103]
  v_mfma_f32_16x16x32_bf16 v[104:107], a[160:163], v[224:227], v[104:107]
  s_nop 2
  v_add_f32 v56, 0x358637bd, v108
  v_rcp_f32 v56, v56
  s_nop 0
  v_pk_mul_f32 v[88:89], v[88:89], v[56:57] op_sel_hi:[1,0]
  v_pk_mul_f32 v[90:91], v[90:91], v[56:57] op_sel_hi:[1,0]
  v_pk_mul_f32 v[92:93], v[92:93], v[56:57] op_sel_hi:[1,0]
  v_pk_mul_f32 v[94:95], v[94:95], v[56:57] op_sel_hi:[1,0]
  v_pk_mul_f32 v[96:97], v[96:97], v[56:57] op_sel_hi:[1,0]
  v_pk_mul_f32 v[98:99], v[98:99], v[56:57] op_sel_hi:[1,0]
  v_pk_mul_f32 v[100:101], v[100:101], v[56:57] op_sel_hi:[1,0]
  v_pk_mul_f32 v[102:103], v[102:103], v[56:57] op_sel_hi:[1,0]
  v_pk_mul_f32 v[104:105], v[104:105], v[56:57] op_sel_hi:[1,0]
  v_pk_mul_f32 v[106:107], v[106:107], v[56:57] op_sel_hi:[1,0]
  v_cvt_pk_bf16_f32 v236, v104, v105
  v_cvt_pk_bf16_f32 v237, v106, v107
  v_cvt_pk_bf16_f32 v228, v88, v89
  v_cvt_pk_bf16_f32 v229, v90, v91
  v_cvt_pk_bf16_f32 v230, v92, v93
  v_cvt_pk_bf16_f32 v231, v94, v95
  v_cvt_pk_bf16_f32 v232, v96, v97
  v_cvt_pk_bf16_f32 v233, v98, v99
  v_cvt_pk_bf16_f32 v234, v100, v101
  v_cvt_pk_bf16_f32 v235, v102, v103
  v_permlane32_swap_b32 v236, v238
  v_permlane32_swap_b32 v237, v239
  s_cmp_eq_u32 s3, 1
  s_cbranch_scc1 L_ost_fast
  buffer_store_dwordx4 v[228:231], v39, s[36:39], 0 offen sc1
  buffer_store_dwordx4 v[232:235], v39, s[36:39], 0 offen offset:256 sc1
  buffer_store_dwordx4 v[236:239], v40, s[36:39], 0 offen sc1
  s_waitcnt vmcnt(0)
  s_mov_b64 exec, 1
  buffer_store_dword v241, v240, s[36:39], 0 offen sc1
  s_mov_b64 exec, -1
  s_branch L_ost_done
L_ost_fast:
  buffer_store_dwordx4 v[228:231], v39, s[36:39], 0 offen
  buffer_store_dwordx4 v[232:235], v39, s[36:39], 0 offen offset:256
  buffer_store_dwordx4 v[236:239], v40, s[36:39], 0 offen
  s_waitcnt vmcnt(0)
  s_mov_b64 exec, 1
  buffer_store_dword v241, v240, s[36:39], 0 offen
  s_mov_b64 exec, -1
L_ost_done:
  s_mul_i32 s63, s40, 40960
  s_add_u32 s63, s63, 491520
  s_add_u32 m0, s60, 112640
  s_nop 0
  buffer_load_dwordx4 v8, s[24:27], s63 offen lds
  s_add_u32 m0, s60, 113664
  s_nop 0
  buffer_load_dwordx4 v9, s[24:27], s63 offen lds
  s_add_u32 m0, s60, 114688
  s_nop 0
  buffer_load_dwordx4 v49, s[24:27], s63 offen lds
  s_add_u32 m0, s60, 115712
  s_nop 0
  buffer_load_dwordx4 v51, s[24:27], s63 offen lds
  s_add_u32 m0, s60, 116736
  s_nop 0
  buffer_load_dwordx4 v253, s[24:27], s63 offen lds
  s_waitcnt vmcnt(0)
  s_barrier
  s_mov_b32 s56, 0
  buffer_load_dword v50, v48, s[36:39], 0 offen sc1
  ds_read_b64_tr_b16 a[0:1], v41 offset:0
  ds_read_b64_tr_b16 a[2:3], v41 offset:2560
  ds_read_b64_tr_b16 a[4:5], v41 offset:8
  ds_read_b64_tr_b16 a[6:7], v41 offset:2568
  ds_read_b64_tr_b16 a[8:9], v41 offset:16
  ds_read_b64_tr_b16 a[10:11], v41 offset:2576
  ds_read_b64_tr_b16 a[12:13], v41 offset:24
  ds_read_b64_tr_b16 a[14:15], v41 offset:2584
  ds_read_b64_tr_b16 a[16:17], v41 offset:32
  ds_read_b64_tr_b16 a[18:19], v41 offset:2592
  ds_read_b64_tr_b16 a[20:21], v41 offset:5120
  ds_read_b64_tr_b16 a[22:23], v41 offset:7680
  ds_read_b64_tr_b16 a[24:25], v41 offset:5128
  ds_read_b64_tr_b16 a[26:27], v41 offset:7688
  ds_read_b64_tr_b16 a[28:29], v41 offset:5136
  ds_read_b64_tr_b16 a[30:31], v41 offset:7696
  ds_read_b64_tr_b16 a[32:33], v41 offset:5144
  ds_read_b64_tr_b16 a[34:35], v41 offset:7704
  ds_read_b64_tr_b16 a[36:37], v41 offset:5152
  ds_read_b64_tr_b16 a[38:39], v41 offset:7712
  ds_read_b64_tr_b16 a[40:41], v41 offset:10240
  ds_read_b64_tr_b16 a[42:43], v41 offset:12800
  ds_read_b64_tr_b16 a[44:45], v41 offset:10248
  ds_read_b64_tr_b16 a[46:47], v41 offset:12808
  ds_read_b64_tr_b16 a[48:49], v41 offset:10256
  ds_read_b64_tr_b16 a[50:51], v41 offset:12816
  ds_read_b64_tr_b16 a[52:53], v41 offset:10264
  ds_read_b64_tr_b16 a[54:55], v41 offset:12824
  ds_read_b64_tr_b16 a[56:57], v41 offset:10272
  ds_read_b64_tr_b16 a[58:59], v41 offset:12832
  s_branch L_h2_chk
L_h2_poll:
  buffer_load_dword v50, v48, s[36:39], 0 offen sc1
L_h2_chk:
  s_add_u32 s56, s56, 1
  s_cmp_gt_u32 s56, 20000
  s_cbranch_scc1 L_h2_go
  s_waitcnt vmcnt(0)
  v_cmp_ne_u32 vcc, s62, v50
  s_nop 1
  s_and_b32 s48, vcc_lo, 0xffff
  s_cbranch_scc1 L_h2_poll
L_h2_go:
  s_movk_i32 s49, 4096
  s_movk_i32 s50, 8192
  s_movk_i32 s51, 12288
  s_movk_i32 s52, 16384
  buffer_load_dwordx4 v[136:139], v42, s[36:39], 0 offen offset:0 sc1
  buffer_load_dwordx4 v[140:143], v42, s[36:39], 0 offen offset:1024 sc1
  buffer_load_dwordx4 v[144:147], v42, s[36:39], 0 offen offset:2048 sc1
  buffer_load_dwordx4 v[148:151], v42, s[36:39], 0 offen offset:3072 sc1
  buffer_load_dwordx4 v[152:155], v42, s[36:39], s49 offen offset:0 sc1
  buffer_load_dwordx4 v[156:159], v42, s[36:39], s49 offen offset:1024 sc1
  buffer_load_dwordx4 v[160:163], v42, s[36:39], s49 offen offset:2048 sc1
  buffer_load_dwordx4 v[164:167], v42, s[36:39], s49 offen offset:3072 sc1
  s_waitcnt vmcnt(7)
  s_waitcnt lgkmcnt(15)
  v_mfma_f32_16x16x32_bf16 v[64:67], a[0:3], v[136:139], 0
  ds_read_b64_tr_b16 a[60:61], v41 offset:15360
  ds_read_b64_tr_b16 a[62:63], v41 offset:17920
  v_mfma_f32_16x16x32_bf16 v[68:71], a[4:7], v[136:139], 0
  ds_read_b64_tr_b16 a[64:65], v41 offset:15368
  ds_read_b64_tr_b16 a[66:67], v41 offset:17928
  buffer_load_dwordx4 v[168:171], v42, s[36:39], s50 offen offset:0 sc1
  v_mfma_f32_16x16x32_bf16 v[72:75], a[8:11], v[136:139], 0
  ds_read_b64_tr_b16 a[68:69], v41 offset:15376
  ds_read_b64_tr_b16 a[70:71], v41 offset:17936
  v_mfma_f32_16x16x32_bf16 v[76:79], a[12:15], v[136:139], 0
  ds_read_b64_tr_b16 a[72:73], v41 offset:15384
  ds_read_b64_tr_b16 a[74:75], v41 offset:17944
  buffer_load_dwordx4 v[172:175], v42, s[36:39], s50 offen offset:1024 sc1
  v_mfma_f32_16x16x32_bf16 v[80:83], a[16:19], v[136:139], 0
  ds_read_b64_tr_b16 a[76:77], v41 offset:15392
  ds_read_b64_tr_b16 a[78:79], v41 offset:17952
  s_waitcnt vmcnt(8)
  s_waitcnt lgkmcnt(15)
  v_mfma_f32_16x16x32_bf16 v[64:67], a[20:23], v[140:143], v[64:67]
  ds_read_b64_tr_b16 a[80:81], v41 offset:20480
  ds_read_b64_tr_b16 a[82:83], v41 offset:23040
  v_mfma_f32_16x16x32_bf16 v[68:71], a[24:27], v[140:143], v[68:71]
  ds_read_b64_tr_b16 a[84:85], v41 offset:20488
  ds_read_b64_tr_b16 a[86:87], v41 offset:23048
  buffer_load_dwordx4 v[176:179], v42, s[36:39], s50 offen offset:2048 sc1
  v_mfma_f32_16x16x32_bf16 v[72:75], a[28:31], v[140:143], v[72:75]
  ds_read_b64_tr_b16 a[88:89], v41 offset:20496
  ds_read_b64_tr_b16 a[90:91], v41 offset:23056
  v_mfma_f32_16x16x32_bf16 v[76:79], a[32:35], v[140:143], v[76:79]
  ds_read_b64_tr_b16 a[92:93], v41 offset:20504
  ds_read_b64_tr_b16 a[94:95], v41 offset:23064
  buffer_load_dwordx4 v[180:183], v42, s[36:39], s50 offen offset:3072 sc1
  v_mfma_f32_16x16x32_bf16 v[80:83], a[36:39], v[140:143], v[80:83]
  ds_read_b64_tr_b16 a[96:97], v41 offset:20512
  ds_read_b64_tr_b16 a[98:99], v41 offset:23072
  s_waitcnt vmcnt(9)
  s_waitcnt lgkmcnt(15)
  v_mfma_f32_16x16x32_bf16 v[64:67], a[40:43], v[144:147], v[64:67]
  ds_read_b64_tr_b16 a[100:101], v41 offset:25600
  ds_read_b64_tr_b16 a[102:103], v41 offset:28160
  v_mfma_f32_16x16x32_bf16 v[68:71], a[44:47], v[144:147], v[68:71]
  ds_read_b64_tr_b16 a[104:105], v41 offset:25608
  ds_read_b64_tr_b16 a[106:107], v41 offset:28168
  buffer_load_dwordx4 v[184:187], v42, s[36:39], s51 offen offset:0 sc1
  v_mfma_f32_16x16x32_bf16 v[72:75], a[48:51], v[144:147], v[72:75]
  ds_read_b64_tr_b16 a[108:109], v41 offset:25616
  ds_read_b64_tr_b16 a[110:111], v41 offset:28176
  v_mfma_f32_16x16x32_bf16 v[76:79], a[52:55], v[144:147], v[76:79]
  ds_read_b64_tr_b16 a[112:113], v41 offset:25624
  ds_read_b64_tr_b16 a[114:115], v41 offset:28184
  buffer_load_dwordx4 v[188:191], v42, s[36:39], s51 offen offset:1024 sc1
  v_mfma_f32_16x16x32_bf16 v[80:83], a[56:59], v[144:147], v[80:83]
  ds_read_b64_tr_b16 a[116:117], v41 offset:25632
  ds_read_b64_tr_b16 a[118:119], v41 offset:28192
  s_waitcnt vmcnt(10)
  s_waitcnt lgkmcnt(15)
  v_mfma_f32_16x16x32_bf16 v[64:67], a[60:63], v[148:151], v[64:67]
  ds_read_b64_tr_b16 a[120:121], v41 offset:30720
  ds_read_b64_tr_b16 a[122:123], v41 offset:33280
  v_mfma_f32_16x16x32_bf16 v[68:71], a[64:67], v[148:151], v[68:71]
  ds_read_b64_tr_b16 a[124:125], v41 offset:30728
  ds_read_b64_tr_b16 a[126:127], v41 offset:33288
  buffer_load_dwordx4 v[192:195], v42, s[36:39], s51 offen offset:2048 sc1
  v_mfma_f32_16x16x32_bf16 v[72:75], a[68:71], v[148:151], v[72:75]
  ds_read_b64_tr_b16 a[128:129], v41 offset:30736
  ds_read_b64_tr_b16 a[130:131], v41 offset:33296
  v_mfma_f32_16x16x32_bf16 v[76:79], a[72:75], v[148:151], v[76:79]
  ds_read_b64_tr_b16 a[132:133], v41 offset:30744
  ds_read_b64_tr_b16 a[134:135], v41 offset:33304
  buffer_load_dwordx4 v[196:199], v42, s[36:39], s51 offen offset:3072 sc1
  v_mfma_f32_16x16x32_bf16 v[80:83], a[76:79], v[148:151], v[80:83]
  ds_read_b64_tr_b16 a[136:137], v41 offset:30752
  ds_read_b64_tr_b16 a[138:139], v41 offset:33312
  s_waitcnt vmcnt(11)
  s_waitcnt lgkmcnt(15)
  v_mfma_f32_16x16x32_bf16 v[64:67], a[80:83], v[152:155], v[64:67]
  ds_read_b64_tr_b16 a[140:141], v41 offset:35840
  ds_read_b64_tr_b16 a[142:143], v41 offset:38400
  v_mfma_f32_16x16x32_bf16 v[68:71], a[84:87], v[152:155], v[68:71]
  ds_read_b64_tr_b16 a[144:145], v41 offset:35848
  ds_read_b64_tr_b16 a[146:147], v41 offset:38408
  buffer_load_dwordx4 v[200:203], v42, s[36:39], s52 offen offset:0 sc1
  v_mfma_f32_16x16x32_bf16 v[72:75], a[88:91], v[152:155], v[72:75]
  ds_read_b64_tr_b16 a[148:149], v41 offset:35856
  ds_read_b64_tr_b16 a[150:151], v41 offset:38416
  v_mfma_f32_16x16x32_bf16 v[76:79], a[92:95], v[152:155], v[76:79]
  ds_read_b64_tr_b16 a[152:153], v41 offset:35864
  ds_read_b64_tr_b16 a[154:155], v41 offset:38424
  buffer_load_dwordx4 v[204:207], v42, s[36:39], s52 offen offset:1024 sc1
  v_mfma_f32_16x16x32_bf16 v[80:83], a[96:99], v[152:155], v[80:83]
  ds_read_b64_tr_b16 a[156:157], v41 offset:35872
  ds_read_b64_tr_b16 a[158:159], v41 offset:38432
  s_waitcnt vmcnt(12)
  s_waitcnt lgkmcnt(15)
  v_mfma_f32_16x16x32_bf16 v[64:67], a[100:103], v[156:159], v[64:67]
  ds_read_b64_tr_b16 a[160:161], v41 offset:40960
  ds_read_b64_tr_b16 a[162:163], v41 offset:43520
  v_mfma_f32_16x16x32_bf16 v[68:71], a[104:107], v[156:159], v[68:71]
  ds_read_b64_tr_b16 a[164:165], v41 offset:40968
  ds_read_b64_tr_b16 a[166:167], v41 offset:43528
  buffer_load_dwordx4 v[208:211], v42, s[36:39], s52 offen offset:2048 sc1
  v_mfma_f32_16x16x32_bf16 v[72:75], a[108:111], v[156:159], v[72:75]
  ds_read_b64_tr_b16 a[168:169], v41 offset:40976
  ds_read_b64_tr_b16 a[170:171], v41 offset:43536
  v_mfma_f32_16x16x32_bf16 v[76:79], a[112:115], v[156:159], v[76:79]
  ds_read_b64_tr_b16 a[172:173], v41 offset:40984
  ds_read_b64_tr_b16 a[174:175], v41 offset:43544
  buffer_load_dwordx4 v[212:215], v42, s[36:39], s52 offen offset:3072 sc1
  v_mfma_f32_16x16x32_bf16 v[80:83], a[116:119], v[156:159], v[80:83]
  ds_read_b64_tr_b16 a[176:177], v41 offset:40992
  ds_read_b64_tr_b16 a[178:179], v41 offset:43552
  s_waitcnt vmcnt(13)
  s_waitcnt lgkmcnt(15)
  v_mfma_f32_16x16x32_bf16 v[64:67], a[120:123], v[160:163], v[64:67]
  ds_read_b64_tr_b16 a[180:181], v41 offset:46080
  ds_read_b64_tr_b16 a[182:183], v41 offset:48640
  v_mfma_f32_16x16x32_bf16 v[68:71], a[124:127], v[160:163], v[68:71]
  ds_read_b64_tr_b16 a[184:185], v41 offset:46088
  ds_read_b64_tr_b16 a[186:187], v41 offset:48648
  v_mfma_f32_16x16x32_bf16 v[72:75], a[128:131], v[160:163], v[72:75]
  ds_read_b64_tr_b16 a[188:189], v41 offset:46096
  ds_read_b64_tr_b16 a[190:191], v41 offset:48656
  v_mfma_f32_16x16x32_bf16 v[76:79], a[132:135], v[160:163], v[76:79]
  ds_read_b64_tr_b16 a[192:193], v41 offset:46104
  ds_read_b64_tr_b16 a[194:195], v41 offset:48664
  v_mfma_f32_16x16x32_bf16 v[80:83], a[136:139], v[160:163], v[80:83]
  ds_read_b64_tr_b16 a[196:197], v41 offset:46112
  ds_read_b64_tr_b16 a[198:199], v41 offset:48672
  s_waitcnt vmcnt(12)
  s_waitcnt lgkmcnt(15)
  v_mfma_f32_16x16x32_bf16 v[64:67], a[140:143], v[164:167], v[64:67]
  ds_read_b64_tr_b16 a[200:201], v44 offset:0
  ds_read_b64_tr_b16 a[202:203], v44 offset:2560
  v_mfma_f32_16x16x32_bf16 v[68:71], a[144:147], v[164:167], v[68:71]
  ds_read_b64_tr_b16 a[204:205], v44 offset:8
  ds_read_b64_tr_b16 a[206:207], v44 offset:2568
  v_mfma_f32_16x16x32_bf16 v[72:75], a[148:151], v[164:167], v[72:75]
  ds_read_b64_tr_b16 a[208:209], v44 offset:16
  ds_read_b64_tr_b16 a[210:211], v44 offset:2576
  v_mfma_f32_16x16x32_bf16 v[76:79], a[152:155], v[164:167], v[76:79]
  ds_read_b64_tr_b16 a[212:213], v44 offset:24
  ds_read_b64_tr_b16 a[214:215], v44 offset:2584
  v_mfma_f32_16x16x32_bf16 v[80:83], a[156:159], v[164:167], v[80:83]
  ds_read_b64_tr_b16 a[216:217], v44 offset:32
  ds_read_b64_tr_b16 a[218:219], v44 offset:2592
  s_waitcnt vmcnt(11)
  s_waitcnt lgkmcnt(15)
  v_mfma_f32_16x16x32_bf16 v[64:67], a[160:163], v[168:171], v[64:67]
  ds_read_b64_tr_b16 a[220:221], v44 offset:5120
  ds_read_b64_tr_b16 a[222:223], v44 offset:7680
  v_mfma_f32_16x16x32_bf16 v[68:71], a[164:167], v[168:171], v[68:71]
  ds_read_b64_tr_b16 a[224:225], v44 offset:5128
  ds_read_b64_tr_b16 a[226:227], v44 offset:7688
  v_mfma_f32_16x16x32_bf16 v[72:75], a[168:171], v[168:171], v[72:75]
  ds_read_b64_tr_b16 a[228:229], v44 offset:5136
  ds_read_b64_tr_b16 a[230:231], v44 offset:7696
  v_mfma_f32_16x16x32_bf16 v[76:79], a[172:175], v[168:171], v[76:79]
  ds_read_b64_tr_b16 a[232:233], v44 offset:5144
  ds_read_b64_tr_b16 a[234:235], v44 offset:7704
  v_mfma_f32_16x16x32_bf16 v[80:83], a[176:179], v[168:171], v[80:83]
  ds_read_b64_tr_b16 a[236:237], v44 offset:5152
  ds_read_b64_tr_b16 a[238:239], v44 offset:7712
  s_waitcnt vmcnt(10)
  s_waitcnt lgkmcnt(15)
  v_mfma_f32_16x16x32_bf16 v[64:67], a[180:183], v[172:175], v[64:67]
  ds_read_b64_tr_b16 a[0:1], v44 offset:10240
  ds_read_b64_tr_b16 a[2:3], v44 offset:12800
  v_mfma_f32_16x16x32_bf16 v[68:71], a[184:187], v[172:175], v[68:71]
  ds_read_b64_tr_b16 a[4:5], v44 offset:10248
  ds_read_b64_tr_b16 a[6:7], v44 offset:12808
  v_mfma_f32_16x16x32_bf16 v[72:75], a[188:191], v[172:175], v[72:75]
  ds_read_b64_tr_b16 a[8:9], v44 offset:10256
  ds_read_b64_tr_b16 a[10:11], v44 offset:12816
  v_mfma_f32_16x16x32_bf16 v[76:79], a[192:195], v[172:175], v[76:79]
  ds_read_b64_tr_b16 a[12:13], v44 offset:10264
  ds_read_b64_tr_b16 a[14:15], v44 offset:12824
  v_mfma_f32_16x16x32_bf16 v[80:83], a[196:199], v[172:175], v[80:83]
  ds_read_b64_tr_b16 a[16:17], v44 offset:10272
  ds_read_b64_tr_b16 a[18:19], v44 offset:12832
  s_waitcnt vmcnt(9)
  s_waitcnt lgkmcnt(15)
  v_mfma_f32_16x16x32_bf16 v[64:67], a[200:203], v[176:179], v[64:67]
  ds_read_b64_tr_b16 a[20:21], v44 offset:15360
  ds_read_b64_tr_b16 a[22:23], v44 offset:17920
  v_mfma_f32_16x16x32_bf16 v[68:71], a[204:207], v[176:179], v[68:71]
  ds_read_b64_tr_b16 a[24:25], v44 offset:15368
  ds_read_b64_tr_b16 a[26:27], v44 offset:17928
  v_mfma_f32_16x16x32_bf16 v[72:75], a[208:211], v[176:179], v[72:75]
  ds_read_b64_tr_b16 a[28:29], v44 offset:15376
  ds_read_b64_tr_b16 a[30:31], v44 offset:17936
  v_mfma_f32_16x16x32_bf16 v[76:79], a[212:215], v[176:179], v[76:79]
  ds_read_b64_tr_b16 a[32:33], v44 offset:15384
  ds_read_b64_tr_b16 a[34:35], v44 offset:17944
  v_mfma_f32_16x16x32_bf16 v[80:83], a[216:219], v[176:179], v[80:83]
  ds_read_b64_tr_b16 a[36:37], v44 offset:15392
  ds_read_b64_tr_b16 a[38:39], v44 offset:17952
  s_waitcnt vmcnt(8)
  s_waitcnt lgkmcnt(15)
  v_mfma_f32_16x16x32_bf16 v[64:67], a[220:223], v[180:183], v[64:67]
  ds_read_b64_tr_b16 a[40:41], v44 offset:20480
  ds_read_b64_tr_b16 a[42:43], v44 offset:23040
  v_mfma_f32_16x16x32_bf16 v[68:71], a[224:227], v[180:183], v[68:71]
  ds_read_b64_tr_b16 a[44:45], v44 offset:20488
  ds_read_b64_tr_b16 a[46:47], v44 offset:23048
  v_mfma_f32_16x16x32_bf16 v[72:75], a[228:231], v[180:183], v[72:75]
  ds_read_b64_tr_b16 a[48:49], v44 offset:20496
  ds_read_b64_tr_b16 a[50:51], v44 offset:23056
  v_mfma_f32_16x16x32_bf16 v[76:79], a[232:235], v[180:183], v[76:79]
  ds_read_b64_tr_b16 a[52:53], v44 offset:20504
  ds_read_b64_tr_b16 a[54:55], v44 offset:23064
  v_mfma_f32_16x16x32_bf16 v[80:83], a[236:239], v[180:183], v[80:83]
  ds_read_b64_tr_b16 a[56:57], v44 offset:20512
  ds_read_b64_tr_b16 a[58:59], v44 offset:23072
  s_waitcnt vmcnt(7)
  s_waitcnt lgkmcnt(15)
  v_mfma_f32_16x16x32_bf16 v[64:67], a[0:3], v[184:187], v[64:67]
  ds_read_b64_tr_b16 a[60:61], v44 offset:25600
  ds_read_b64_tr_b16 a[62:63], v44 offset:28160
  v_mfma_f32_16x16x32_bf16 v[68:71], a[4:7], v[184:187], v[68:71]
  ds_read_b64_tr_b16 a[64:65], v44 offset:25608
  ds_read_b64_tr_b16 a[66:67], v44 offset:28168
  v_mfma_f32_16x16x32_bf16 v[72:75], a[8:11], v[184:187], v[72:75]
  ds_read_b64_tr_b16 a[68:69], v44 offset:25616
  ds_read_b64_tr_b16 a[70:71], v44 offset:28176
  v_mfma_f32_16x16x32_bf16 v[76:79], a[12:15], v[184:187], v[76:79]
  ds_read_b64_tr_b16 a[72:73], v44 offset:25624
  ds_read_b64_tr_b16 a[74:75], v44 offset:28184
  v_mfma_f32_16x16x32_bf16 v[80:83], a[16:19], v[184:187], v[80:83]
  ds_read_b64_tr_b16 a[76:77], v44 offset:25632
  ds_read_b64_tr_b16 a[78:79], v44 offset:28192
  s_waitcnt vmcnt(6)
  s_waitcnt lgkmcnt(15)
  v_mfma_f32_16x16x32_bf16 v[64:67], a[20:23], v[188:191], v[64:67]
  ds_read_b64_tr_b16 a[80:81], v44 offset:30720
  ds_read_b64_tr_b16 a[82:83], v44 offset:33280
  v_mfma_f32_16x16x32_bf16 v[68:71], a[24:27], v[188:191], v[68:71]
  ds_read_b64_tr_b16 a[84:85], v44 offset:30728
  ds_read_b64_tr_b16 a[86:87], v44 offset:33288
  v_mfma_f32_16x16x32_bf16 v[72:75], a[28:31], v[188:191], v[72:75]
  ds_read_b64_tr_b16 a[88:89], v44 offset:30736
  ds_read_b64_tr_b16 a[90:91], v44 offset:33296
  v_mfma_f32_16x16x32_bf16 v[76:79], a[32:35], v[188:191], v[76:79]
  ds_read_b64_tr_b16 a[92:93], v44 offset:30744
  ds_read_b64_tr_b16 a[94:95], v44 offset:33304
  v_mfma_f32_16x16x32_bf16 v[80:83], a[36:39], v[188:191], v[80:83]
  ds_read_b64_tr_b16 a[96:97], v44 offset:30752
  ds_read_b64_tr_b16 a[98:99], v44 offset:33312
  s_waitcnt vmcnt(5)
  s_waitcnt lgkmcnt(15)
  v_mfma_f32_16x16x32_bf16 v[64:67], a[40:43], v[192:195], v[64:67]
  ds_read_b64_tr_b16 a[100:101], v44 offset:35840
  ds_read_b64_tr_b16 a[102:103], v44 offset:38400
  v_mfma_f32_16x16x32_bf16 v[68:71], a[44:47], v[192:195], v[68:71]
  ds_read_b64_tr_b16 a[104:105], v44 offset:35848
  ds_read_b64_tr_b16 a[106:107], v44 offset:38408
  v_mfma_f32_16x16x32_bf16 v[72:75], a[48:51], v[192:195], v[72:75]
  ds_read_b64_tr_b16 a[108:109], v44 offset:35856
  ds_read_b64_tr_b16 a[110:111], v44 offset:38416
  v_mfma_f32_16x16x32_bf16 v[76:79], a[52:55], v[192:195], v[76:79]
  ds_read_b64_tr_b16 a[112:113], v44 offset:35864
  ds_read_b64_tr_b16 a[114:115], v44 offset:38424
  v_mfma_f32_16x16x32_bf16 v[80:83], a[56:59], v[192:195], v[80:83]
  ds_read_b64_tr_b16 a[116:117], v44 offset:35872
  ds_read_b64_tr_b16 a[118:119], v44 offset:38432
  s_waitcnt vmcnt(4)
  s_waitcnt lgkmcnt(15)
  v_mfma_f32_16x16x32_bf16 v[64:67], a[60:63], v[196:199], v[64:67]
  ds_read_b64_tr_b16 a[120:121], v44 offset:40960
  ds_read_b64_tr_b16 a[122:123], v44 offset:43520
  v_mfma_f32_16x16x32_bf16 v[68:71], a[64:67], v[196:199], v[68:71]
  ds_read_b64_tr_b16 a[124:125], v44 offset:40968
  ds_read_b64_tr_b16 a[126:127], v44 offset:43528
  v_mfma_f32_16x16x32_bf16 v[72:75], a[68:71], v[196:199], v[72:75]
  ds_read_b64_tr_b16 a[128:129], v44 offset:40976
  ds_read_b64_tr_b16 a[130:131], v44 offset:43536
  v_mfma_f32_16x16x32_bf16 v[76:79], a[72:75], v[196:199], v[76:79]
  ds_read_b64_tr_b16 a[132:133], v44 offset:40984
  ds_read_b64_tr_b16 a[134:135], v44 offset:43544
  v_mfma_f32_16x16x32_bf16 v[80:83], a[76:79], v[196:199], v[80:83]
  ds_read_b64_tr_b16 a[136:137], v44 offset:40992
  ds_read_b64_tr_b16 a[138:139], v44 offset:43552
  s_waitcnt vmcnt(3)
  s_waitcnt lgkmcnt(15)
  v_mfma_f32_16x16x32_bf16 v[64:67], a[80:83], v[200:203], v[64:67]
  ds_read_b64_tr_b16 a[140:141], v44 offset:46080
  ds_read_b64_tr_b16 a[142:143], v44 offset:48640
  v_mfma_f32_16x16x32_bf16 v[68:71], a[84:87], v[200:203], v[68:71]
  ds_read_b64_tr_b16 a[144:145], v44 offset:46088
  ds_read_b64_tr_b16 a[146:147], v44 offset:48648
  v_mfma_f32_16x16x32_bf16 v[72:75], a[88:91], v[200:203], v[72:75]
  ds_read_b64_tr_b16 a[148:149], v44 offset:46096
  ds_read_b64_tr_b16 a[150:151], v44 offset:48656
  v_mfma_f32_16x16x32_bf16 v[76:79], a[92:95], v[200:203], v[76:79]
  ds_read_b64_tr_b16 a[152:153], v44 offset:46104
  ds_read_b64_tr_b16 a[154:155], v44 offset:48664
  v_mfma_f32_16x16x32_bf16 v[80:83], a[96:99], v[200:203], v[80:83]
  ds_read_b64_tr_b16 a[156:157], v44 offset:46112
  ds_read_b64_tr_b16 a[158:159], v44 offset:48672
  s_waitcnt vmcnt(2)
  s_waitcnt lgkmcnt(15)
  v_mfma_f32_16x16x32_bf16 v[64:67], a[100:103], v[204:207], v[64:67]
  v_mfma_f32_16x16x32_bf16 v[68:71], a[104:107], v[204:207], v[68:71]
  v_mfma_f32_16x16x32_bf16 v[72:75], a[108:111], v[204:207], v[72:75]
  v_mfma_f32_16x16x32_bf16 v[76:79], a[112:115], v[204:207], v[76:79]
  v_mfma_f32_16x16x32_bf16 v[80:83], a[116:119], v[204:207], v[80:83]
  s_waitcnt vmcnt(1)
  s_waitcnt lgkmcnt(10)
  v_mfma_f32_16x16x32_bf16 v[64:67], a[120:123], v[208:211], v[64:67]
  v_mfma_f32_16x16x32_bf16 v[68:71], a[124:127], v[208:211], v[68:71]
  v_mfma_f32_16x16x32_bf16 v[72:75], a[128:131], v[208:211], v[72:75]
  v_mfma_f32_16x16x32_bf16 v[76:79], a[132:135], v[208:211], v[76:79]
  v_mfma_f32_16x16x32_bf16 v[80:83], a[136:139], v[208:211], v[80:83]
  s_waitcnt vmcnt(0)
  s_waitcnt lgkmcnt(0)
  v_mfma_f32_16x16x32_bf16 v[64:67], a[140:143], v[212:215], v[64:67]
  v_mfma_f32_16x16x32_bf16 v[68:71], a[144:147], v[212:215], v[68:71]
  v_mfma_f32_16x16x32_bf16 v[72:75], a[148:151], v[212:215], v[72:75]
  v_mfma_f32_16x16x32_bf16 v[76:79], a[152:155], v[212:215], v[76:79]
  v_mfma_f32_16x16x32_bf16 v[80:83], a[156:159], v[212:215], v[80:83]
  s_nop 3
  v_cvt_pk_bf16_f32 v228, v64, v65
  v_cvt_pk_bf16_f32 v229, v66, v67
  v_cvt_pk_bf16_f32 v230, v68, v69
  v_cvt_pk_bf16_f32 v231, v70, v71
  buffer_store_dwordx4 v[228:231], v46, s[28:31], 0 offen
  v_cvt_pk_bf16_f32 v232, v72, v73
  v_cvt_pk_bf16_f32 v233, v74, v75
  v_cvt_pk_bf16_f32 v234, v76, v77
  v_cvt_pk_bf16_f32 v235, v78, v79
  buffer_store_dwordx4 v[232:235], v46, s[28:31], 0 offen offset:16
  v_cvt_pk_bf16_f32 v236, v80, v81
  v_cvt_pk_bf16_f32 v237, v82, v83
  buffer_store_dwordx2 v[236:237], v46, s[28:31], 0 offen offset:32
  s_or_b32 s48, s2, s40
  s_cmp_lg_u32 s48, 0
  s_cbranch_scc1 L_noep
  v_mov_b32 v56, 1015808
  v_mov_b32 v57, s61
  s_mov_b64 exec, 1
  buffer_store_dword v57, v56, s[36:39], 0 offen sc1
  s_mov_b64 exec, -1
L_noep:
L_end:
  s_endpgm
.section .rodata,"a"
.p2align 6
.amdhsa_kernel standalone__linear_kernel_hedgehog__prompt_kernel
  .amdhsa_next_free_vgpr 512
  .amdhsa_next_free_sgpr 102
  .amdhsa_accum_offset 256
  .amdhsa_group_segment_fixed_size 0
  .amdhsa_kernarg_size 56
  .amdhsa_user_sgpr_count 2
  .amdhsa_user_sgpr_kernarg_segment_ptr 1
  .amdhsa_system_sgpr_workgroup_id_x 1
  .amdhsa_float_denorm_mode_32 3
  .amdhsa_float_denorm_mode_16_64 3
.end_amdhsa_kernel
```
